```python
import torch

def _softmax(x, axis=-1):
    return torch.softmax(x, dim=axis)
def _gelu(x):
    return torch.nn.functional.gelu(x, approximate="tanh")
def _silu(x):
    return torch.nn.functional.silu(x)
def _sigmoid(x):
    return torch.sigmoid(x)
def _layernorm(x, axis=-1, eps=1e-5):
    m = x.mean(dim=axis, keepdim=True)
    v = x.var(dim=axis, keepdim=True, unbiased=False)
    return (x - m) / torch.sqrt(v + eps)
def _scatter_add(tgt, idx, src, axis=0):
    return tgt.clone().index_add_(axis, idx, src)
def _segment_sum(src, seg, n):
    out = torch.zeros((n,) + src.shape[1:], dtype=src.dtype)
    return out.index_add_(0, seg, src)
def _pad(x, pw):
    flat = tuple(v for pair in reversed(pw) for v in pair)
    return torch.nn.functional.pad(x, flat)

kernel_name = 'parallel_sum__linear_attn_block__dense_activation_gelu__prompt'

def setup_inputs():

    _w = (lambda a: (lambda t: t.to(torch.bfloat16) if t.is_floating_point() else t)(torch.as_tensor(a)))
    def _A_setup():
        B, S, D = 1, 2048, 512
        return {
            "x": _w((lambda *s: torch.randn(*s, dtype=torch.bfloat16) * 0.05)(B, S, D)),
            "wqkv": _w((lambda *s: torch.randn(*s, dtype=torch.bfloat16) * 0.2)(D, 3 * D)),
            "wo": _w((lambda *s: torch.randn(*s, dtype=torch.bfloat16) * 0.05)(D, D)),
        }
    _A_in = _A_setup()

    def _B_setup():
        B, S, D, F = 1, 2048, 512, 1792
        return {
            "x": _w((lambda *s: torch.randn(*s, dtype=torch.bfloat16) * 0.05)(B, S, D)),
            "w1": _w((lambda *s: torch.randn(*s, dtype=torch.bfloat16) * 0.8)(D, F) * (D ** -0.5)),
            "b1": _w((lambda *s: torch.randn(*s, dtype=torch.bfloat16) * 12.8)(F) * 0.01),
            "w2": _w((lambda *s: torch.randn(*s, dtype=torch.bfloat16) * 0.8)(F, D) * (F ** -0.5)),
            "b2": _w((lambda *s: torch.randn(*s, dtype=torch.bfloat16) * 12.8)(D) * 0.01),
        }
    _B_in = _B_setup()

    return {
        "A_x": _A_in["x"],
        "A_wqkv": _A_in["wqkv"],
        "A_wo": _A_in["wo"],
        "B_x": _B_in["x"],
        "B_w1": _B_in["w1"],
        "B_b1": _B_in["b1"],
        "B_w2": _B_in["w2"],
        "B_b2": _B_in["b2"],
    }

def reference(A_x, A_wqkv, A_wo, B_x, B_w1, B_b1, B_w2, B_b2):
    def _A_ref(x, wqkv, wo):
        B, S, D = x.shape
        H = 32; Dh = D // H
        qkv = (lambda x, *d: x.permute(*d))((x @ wqkv).reshape(B, S, 3, H, Dh), 2, 0, 3, 1, 4)
        q, k, v = qkv[0], qkv[1], qkv[2]
        phi = lambda t: torch.where(t > 0, t + 1, torch.exp(t)) + 1e-6
        pq, pk = phi(q), phi(k)
        kv = torch.einsum("bhsd,bhse->bhde", pk, v)
        z = torch.einsum("bhsd->bhd", pk)
        num = torch.einsum("bhqd,bhde->bhqe", pq, kv)
        den = torch.einsum("bhqd,bhd->bhq", pq, z)[..., None] + 1e-6
        o = num / den
        return (lambda x, *d: x.permute(*d))(o, 0, 2, 1, 3).reshape(B, S, D) @ wo

    def _B_ref(x, w1, b1, w2, b2):
        h = torch.einsum("bsd,df->bsf", x, w1) + b1
        h = _gelu(h)
        return torch.einsum("bsf,fd->bsd", h, w2) + b2

    x = A_x
    xn = _layernorm(x, axis=-1)
    return x + _A_ref(xn, A_wqkv, A_wo) + _B_ref(xn, B_w1, B_b1, B_w2, B_b2)
```

```asm
; @launch grid=(256,1,1) block=(512,1,1) lds=163840
.amdgcn_target "amdgcn-amd-amdhsa--gfx950"
.text
.globl parallel_sum__linear_attn_block__dense_activation_gelu__prompt_kernel
.p2align 8
.type parallel_sum__linear_attn_block__dense_activation_gelu__prompt_kernel,@function
parallel_sum__linear_attn_block__dense_activation_gelu__prompt_kernel:
    s_cmp_ge_u32 s2, 256
    s_cbranch_scc1 L_exit
    s_load_dwordx16 s[64:79], s[0:1], 0
    s_load_dwordx4 s[80:83], s[0:1], 64
    s_load_dwordx2 s[84:85], s[0:1], 80
    v_lshrrev_b32 v2, 6, v0
    v_and_b32 v1, 63, v0
    v_readfirstlane_b32 s44, v2
    s_nop 0
    s_and_b32 s45, s44, 3
    s_lshr_b32 s46, s44, 2
    s_lshl_b32 s49, s44, 10
    s_lshl_b32 s50, s44, 11
    s_and_b32 s56, s2, 7
    s_lshr_b32 s57, s2, 3
    s_lshr_b32 s63, s57, 2
    s_and_b32 s47, s56, 1
    s_lshl_b32 s47, s47, 3
    s_add_u32 s47, s47, s63
    s_and_b32 s48, s56, 6
    s_and_b32 s58, s57, 1
    s_add_u32 s48, s48, s58
    s_and_b32 s58, s57, 2
    s_lshl_b32 s58, s58, 2
    s_add_u32 s48, s48, s58
    s_and_b32 s58, s57, 3
    s_lshl_b32 s58, s58, 1
    s_add_u32 s63, s63, s58
    s_lshr_b32 s59, s57, 3
    s_lshl_b32 s58, s56, 2
    s_add_u32 s59, s59, s58
    s_and_b32 s60, s57, 7
    v_lshlrev_b32 v6, 4, v1
    s_waitcnt lgkmcnt(0)
    s_mov_b32 s4, s64
    s_mov_b32 s5, s65
    s_mov_b32 s6, 2097152
    s_mov_b32 s7, 0x00020000
    s_mov_b32 s8, s66
    s_mov_b32 s9, s67
    s_mov_b32 s10, 1572864
    s_mov_b32 s11, 0x00020000
    s_mov_b32 s24, s68
    s_mov_b32 s25, s69
    s_mov_b32 s26, 524288
    s_mov_b32 s27, 0x00020000
    s_mov_b32 s12, s72
    s_mov_b32 s13, s73
    s_mov_b32 s14, 1835008
    s_mov_b32 s15, 0x00020000
    s_mov_b32 s32, s74
    s_mov_b32 s33, s75
    s_mov_b32 s34, 3584
    s_mov_b32 s35, 0x00020000
    s_mov_b32 s20, s76
    s_mov_b32 s21, s77
    s_mov_b32 s22, 1835008
    s_mov_b32 s23, 0x00020000
    s_mov_b32 s36, s78
    s_mov_b32 s37, s79
    s_mov_b32 s38, 1024
    s_mov_b32 s39, 0x00020000
    s_mov_b32 s28, s80
    s_mov_b32 s29, s81
    s_mov_b32 s30, 2097152
    s_mov_b32 s31, 0x00020000
    s_mov_b32 s40, s82
    s_mov_b32 s41, s83
    s_mov_b32 s42, 256
    s_mov_b32 s43, 0x00020000
    s_mov_b32 s16, s84
    s_mov_b32 s17, s85
    s_mov_b32 s18, 17825792
    s_mov_b32 s19, 0x00020000
    v_lshrrev_b32 v48, 4, v1
    v_and_b32 v49, 7, v1
    v_xor_b32 v48, v48, v49
    v_lshlrev_b32 v48, 4, v48
    v_lshrrev_b32 v49, 3, v1
    v_lshl_add_u32 v12, v49, 10, v48
    v_xor_b32 v13, 64, v12
    v_add_u32 v13, 7168, v13
    s_lshl_b32 s51, s47, 17
    s_lshl_b32 s56, s44, 14
    s_add_u32 s51, s51, s56
    s_cmp_ge_u32 s48, 8
    s_cbranch_scc1 L_roleH
L_roleA:
    v_lshrrev_b32 v48, 3, v1
    v_mul_u32_u24 v4, 3072, v48
    v_lshrrev_b32 v48, 2, v1
    v_and_b32 v48, 4, v48
    v_and_b32 v49, 7, v1
    v_xor_b32 v48, v48, v49
    v_lshl_add_u32 v4, v48, 4, v4
    s_mul_i32 s52, s44, 24576
    s_lshl_b32 s56, s48, 7
    s_add_u32 s52, s52, s56
    s_add_u32 s56, s63, 0
    s_and_b32 s56, s56, 7
    s_lshl_b32 s57, s56, 7
    s_add_u32 s64, s51, s57
    s_mul_i32 s57, s56, 196608
    s_add_u32 s72, s52, s57
    s_add_u32 s56, s63, 1
    s_and_b32 s56, s56, 7
    s_lshl_b32 s57, s56, 7
    s_add_u32 s65, s51, s57
    s_mul_i32 s57, s56, 196608
    s_add_u32 s73, s52, s57
    s_add_u32 m0, s50, 81920
    s_nop 0
    buffer_load_dwordx4 v12, s[4:7], s64 offen lds
    buffer_load_dwordx4 v13, s[4:7], s64 offen offset:1024 lds
    s_add_u32 m0, s50, 98304
    s_add_u32 s56, s72, 1024
    buffer_load_dwordx4 v4, s[8:11], s56 offen lds
    buffer_load_dwordx4 v4, s[8:11], s56 offen offset:1024 lds
    s_add_u32 s56, s63, 2
    s_and_b32 s56, s56, 7
    s_lshl_b32 s57, s56, 7
    s_add_u32 s66, s51, s57
    s_mul_i32 s57, s56, 196608
    s_add_u32 s74, s52, s57
    s_add_u32 s56, s63, 3
    s_and_b32 s56, s56, 7
    s_lshl_b32 s57, s56, 7
    s_add_u32 s67, s51, s57
    s_mul_i32 s57, s56, 196608
    s_add_u32 s75, s52, s57
    s_add_u32 s56, s63, 4
    s_and_b32 s56, s56, 7
    s_lshl_b32 s57, s56, 7
    s_add_u32 s68, s51, s57
    s_mul_i32 s57, s56, 196608
    s_add_u32 s76, s52, s57
    s_add_u32 s56, s63, 5
    s_and_b32 s56, s56, 7
    s_lshl_b32 s57, s56, 7
    s_add_u32 s69, s51, s57
    s_mul_i32 s57, s56, 196608
    s_add_u32 s77, s52, s57
    s_add_u32 s56, s63, 6
    s_and_b32 s56, s56, 7
    s_lshl_b32 s57, s56, 7
    s_add_u32 s70, s51, s57
    s_mul_i32 s57, s56, 196608
    s_add_u32 s78, s52, s57
    s_add_u32 s56, s63, 7
    s_and_b32 s56, s56, 7
    s_lshl_b32 s57, s56, 7
    s_add_u32 s71, s51, s57
    s_mul_i32 s57, s56, 196608
    s_add_u32 s79, s52, s57
    v_lshrrev_b32 v48, 3, v1
    v_mul_u32_u24 v7, 1024, v48
    v_lshrrev_b32 v48, 2, v1
    v_and_b32 v48, 4, v48
    v_and_b32 v49, 7, v1
    v_xor_b32 v48, v48, v49
    v_lshl_add_u32 v7, v48, 4, v7
    v_add_u32 v0, 7168, v7
    s_lshl_b32 s62, s60, 7
    s_lshl_b32 s51, s47, 4
    s_add_u32 s51, s51, s48
    s_lshl_b32 s51, s51, 7
    s_add_u32 s51, s51, 14745600
    s_mov_b32 s3, 1
    s_or_b32 s56, s2, s44
    s_cmp_lg_u32 s56, 0
    s_cbranch_scc1 L_nn1
    s_memrealtime s[56:57]
    s_waitcnt lgkmcnt(0)
    s_or_b32 s56, s56, 1
    v_mov_b32 v48, s56
    v_mov_b32 v49, s57
    v_mov_b32 v50, 0
    buffer_store_dwordx2 v[48:49], v50, s[40:43], 0 offen sc1
L_nn1:
    s_add_u32 m0, s50, 114688
    s_nop 0
    buffer_load_dwordx4 v12, s[4:7], s65 offen lds
    buffer_load_dwordx4 v13, s[4:7], s65 offen offset:1024 lds
    s_add_u32 m0, s50, 131072
    s_add_u32 s56, s73, 1024
    buffer_load_dwordx4 v4, s[8:11], s56 offen lds
    buffer_load_dwordx4 v4, s[8:11], s56 offen offset:1024 lds
    v_lshrrev_b32 v48, 2, v1
    v_mul_u32_u24 v5, 3584, v48
    v_and_b32 v48, 3, v1
    v_lshl_add_u32 v5, v48, 4, v5
    s_lshl_b32 s56, s48, 6
    s_add_u32 s56, s56, 3072
    s_mul_i32 s53, s45, 57344
    s_add_u32 s53, s53, s56
    v_and_b32 v48, 31, v1
    v_lshlrev_b32 v48, 1, v48
    buffer_load_ushort v27, v48, s[32:35], s56 offen
    s_lshl_b32 s54, s47, 2
    s_add_u32 s54, s54, s45
    s_lshl_b32 s55, s54, 7
    s_mul_i32 s54, s54, 147456
    s_lshl_b32 s56, s48, 1
    s_add_u32 s56, s56, s46
    s_lshl_b32 s56, s56, 18
    s_add_u32 s55, s55, s56
    s_add_u32 s55, s55, 10485760
    s_lshl_b32 s56, s48, 12
    s_add_u32 s54, s54, s56
    s_lshl_b32 s56, s46, 11
    s_add_u32 s54, s54, s56
    v_and_b32 v48, 31, v1
    v_lshlrev_b32 v49, 7, v48
    v_bfe_u32 v48, v1, 1, 3
    v_lshrrev_b32 v50, 5, v1
    v_xor_b32 v48, v48, v50
    v_lshl_add_u32 v49, v48, 4, v49
    s_lshl_b32 s56, s45, 12
    v_add_u32 v49, s56, v49
    s_lshl_b32 s56, s46, 6
    v_xor_b32 v8, s56, v49
    v_xor_b32 v9, 32, v8
    v_xor_b32 v10, 64, v8
    v_xor_b32 v11, 96, v8
    v_and_b32 v49, 16, v1
    v_lshlrev_b32 v49, 1, v49
    v_and_b32 v48, 3, v1
    v_lshl_add_u32 v49, v48, 3, v49
    v_and_b32 v48, 8, v1
    v_lshl_add_u32 v49, v48, 3, v49
    v_bfe_u32 v48, v1, 2, 2
    v_lshl_add_u32 v49, v48, 7, v49
    v_xor_b32 v49, s56, v49
    v_lshrrev_b32 v50, 5, v1
    v_lshl_add_u32 v48, v50, 10, v49
    s_lshl_b32 s57, s46, 12
    v_add_u32 v16, s57, v48
    v_xor_b32 v17, 4096, v16
    s_lshl_b32 s57, s45, 11
    v_add_u32 v18, s57, v48
    v_lshl_add_u32 v48, v50, 11, v49
    s_lshl_b32 s57, s46, 13
    v_add_u32 v19, s57, v48
    v_xor_b32 v20, 8192, v19
    s_lshl_b32 s57, s45, 12
    v_add_u32 v21, s57, v48
    v_and_b32 v2, 16, v1
    v_lshlrev_b32 v2, 1, v2
    v_and_b32 v48, 3, v1
    v_lshl_add_u32 v2, v48, 3, v2
    v_bfe_u32 v48, v1, 2, 2
    v_lshl_add_u32 v2, v48, 6, v2
    v_lshl_add_u32 v2, v50, 9, v2
    v_add_u32 v3, s49, v2
    s_lshl_b32 s57, s46, 11
    v_add_u32 v2, s57, v2
    v_and_b32 v48, 31, v1
    v_cmp_eq_u32 vcc, 0, v48
    v_cmp_eq_u32 s[56:57], 20, v48
    s_nop 0
    s_or_b64 vcc, vcc, s[56:57]
    v_mov_b32 v49, 0x3f803f80
    v_cndmask_b32 v36, 0, v49, vcc
    v_mov_b32 v37, v36
    v_mov_b32 v38, v36
    v_mov_b32 v39, v36
    v_lshlrev_b32 v31, 4, v48
    s_lshl_b32 s56, s46, 9
    s_add_u32 s56, s56, 159744
    v_add_u32 v31, s56, v31
    s_lshl_b32 s56, s45, 2
    v_add_u32 v30, s56, v31
    v_mov_b32 v14, 0
    v_mov_b32 v15, 0
    v_mov_b32 v48, 163328
    ds_write_b64 v48, v[14:15]
    s_waitcnt lgkmcnt(0)
    s_waitcnt vmcnt(7)
    s_waitcnt vmcnt(5)
    s_barrier
    v_add_u32 v8, 0x10000, v8
    ds_read_b128 v[128:131], v8 offset:16384
    v_add_u32 v9, 0x10000, v9
    ds_read_b128 v[132:135], v9 offset:16384
    v_add_u32 v10, 0x10000, v10
    ds_read_b128 v[136:139], v10 offset:16384
    v_add_u32 v11, 0x10000, v11
    ds_read_b128 v[140:143], v11 offset:16384
    v_add_u32 v19, 0x10000, v19
    ds_read_b64_tr_b16 v[64:65], v19 offset:32768
    ds_read_b64_tr_b16 v[66:67], v19 offset:33280
    ds_read_b64_tr_b16 v[112:113], v19 offset:33792
    ds_read_b64_tr_b16 v[114:115], v19 offset:34304
    ds_read_b64_tr_b16 v[68:69], v19 offset:36864
    ds_read_b64_tr_b16 v[70:71], v19 offset:37376
    ds_read_b64_tr_b16 v[116:117], v19 offset:37888
    ds_read_b64_tr_b16 v[118:119], v19 offset:38400
    v_add_u32 v20, 0x10000, v20
    ds_read_b64_tr_b16 v[72:73], v20 offset:32768
    ds_read_b64_tr_b16 v[74:75], v20 offset:33280
    ds_read_b64_tr_b16 v[120:121], v20 offset:33792
    ds_read_b64_tr_b16 v[122:123], v20 offset:34304
    ds_read_b64_tr_b16 v[76:77], v20 offset:36864
    ds_read_b64_tr_b16 v[78:79], v20 offset:37376
    ds_read_b64_tr_b16 v[124:125], v20 offset:37888
    ds_read_b64_tr_b16 v[126:127], v20 offset:38400
    v_add_u32 v21, 0x10000, v21
    ds_read_b64_tr_b16 v[56:57], v21 offset:32768
    ds_read_b64_tr_b16 v[58:59], v21 offset:33280
    ds_read_b64_tr_b16 v[60:61], v21 offset:33792
    ds_read_b64_tr_b16 v[62:63], v21 offset:34304
    s_add_u32 m0, s50, 0
    s_nop 0
    buffer_load_dwordx4 v12, s[4:7], s66 offen lds
    buffer_load_dwordx4 v13, s[4:7], s66 offen offset:1024 lds
    s_add_u32 m0, s50, 16384
    s_add_u32 s56, s74, 1024
    buffer_load_dwordx4 v4, s[8:11], s56 offen lds
    buffer_load_dwordx4 v4, s[8:11], s56 offen offset:1024 lds
    s_waitcnt vmcnt(7)
    s_waitcnt vmcnt(5)
    s_barrier
    ds_read_b128 v[144:147], v8 offset:49152
    ds_read_b128 v[148:151], v9 offset:49152
    ds_read_b128 v[152:155], v10 offset:49152
    ds_read_b128 v[156:159], v11 offset:49152
    s_waitcnt lgkmcnt(15)
    v_mfma_f32_32x32x16_bf16 v[80:95], v[128:131], v[64:67], 0
    v_add_u32 v19, 0x10000, v19
    ds_read_b64_tr_b16 v[64:65], v19 offset:0
    ds_read_b64_tr_b16 v[66:67], v19 offset:512
    s_add_u32 m0, s50, 32768
    s_nop 0
    buffer_load_dwordx4 v12, s[4:7], s67 offen lds
    buffer_load_dwordx4 v13, s[4:7], s67 offen offset:1024 lds
    v_lshlrev_b32 v48, 16, v128
    v_and_b32 v49, 0xffff0000, v128
    v_add_f32 v14, v14, v48
    v_fmac_f32 v15, v48, v48
    v_mfma_f32_32x32x16_bf16 v[96:111], v[128:131], v[112:115], 0
    ds_read_b64_tr_b16 v[112:113], v19 offset:1024
    ds_read_b64_tr_b16 v[114:115], v19 offset:1536
    v_add_f32 v14, v14, v49
    v_fmac_f32 v15, v49, v49
    v_lshlrev_b32 v50, 16, v129
    v_and_b32 v51, 0xffff0000, v129
    v_add_f32 v14, v14, v50
    v_mfma_f32_32x32x16_bf16 v[80:95], v[132:135], v[68:71], v[80:95]
    ds_read_b64_tr_b16 v[68:69], v19 offset:4096
    ds_read_b64_tr_b16 v[70:71], v19 offset:4608
    v_fmac_f32 v15, v50, v50
    v_add_f32 v14, v14, v51
    v_fmac_f32 v15, v51, v51
    v_lshlrev_b32 v52, 16, v130
    v_and_b32 v53, 0xffff0000, v130
    v_mfma_f32_32x32x16_bf16 v[96:111], v[132:135], v[116:119], v[96:111]
    ds_read_b64_tr_b16 v[116:117], v19 offset:5120
    ds_read_b64_tr_b16 v[118:119], v19 offset:5632
    s_add_u32 m0, s50, 49152
    s_add_u32 s56, s75, 1024
    buffer_load_dwordx4 v4, s[8:11], s56 offen lds
    buffer_load_dwordx4 v4, s[8:11], s56 offen offset:1024 lds
    v_add_f32 v14, v14, v52
    v_fmac_f32 v15, v52, v52
    v_add_f32 v14, v14, v53
    v_fmac_f32 v15, v53, v53
    v_lshlrev_b32 v54, 16, v131
    s_waitcnt lgkmcnt(14)
    v_mfma_f32_16x16x32_bf16 v[40:43], v[36:39], v[56:59], 0
    v_add_u32 v21, 0x10000, v21
    ds_read_b64_tr_b16 v[56:57], v21 offset:0
    ds_read_b64_tr_b16 v[58:59], v21 offset:512
    v_and_b32 v55, 0xffff0000, v131
    v_add_f32 v14, v14, v54
    v_fmac_f32 v15, v54, v54
    v_add_f32 v14, v14, v55
    v_fmac_f32 v15, v55, v55
    s_waitcnt lgkmcnt(14)
    v_mfma_f32_16x16x32_bf16 v[44:47], v[36:39], v[60:63], 0
    ds_read_b64_tr_b16 v[60:61], v21 offset:1024
    ds_read_b64_tr_b16 v[62:63], v21 offset:1536
    v_lshlrev_b32 v48, 16, v132
    v_and_b32 v49, 0xffff0000, v132
    v_add_f32 v14, v14, v48
    v_fmac_f32 v15, v48, v48
    v_add_f32 v14, v14, v49
    v_mfma_f32_32x32x16_bf16 v[80:95], v[136:139], v[72:75], v[80:95]
    v_add_u32 v20, 0x10000, v20
    ds_read_b64_tr_b16 v[72:73], v20 offset:0
    ds_read_b64_tr_b16 v[74:75], v20 offset:512
    s_add_u32 m0, s50, 65536
    s_nop 0
    buffer_load_dwordx4 v12, s[4:7], s68 offen lds
    buffer_load_dwordx4 v13, s[4:7], s68 offen offset:1024 lds
    v_fmac_f32 v15, v49, v49
    v_lshlrev_b32 v50, 16, v133
    v_and_b32 v51, 0xffff0000, v133
    v_add_f32 v14, v14, v50
    v_fmac_f32 v15, v50, v50
    v_mfma_f32_32x32x16_bf16 v[96:111], v[136:139], v[120:123], v[96:111]
    ds_read_b64_tr_b16 v[120:121], v20 offset:1024
    ds_read_b64_tr_b16 v[122:123], v20 offset:1536
    v_add_f32 v14, v14, v51
    v_fmac_f32 v15, v51, v51
    v_lshlrev_b32 v52, 16, v134
    v_and_b32 v53, 0xffff0000, v134
    v_add_f32 v14, v14, v52
    v_mfma_f32_32x32x16_bf16 v[80:95], v[140:143], v[76:79], v[80:95]
    ds_read_b64_tr_b16 v[76:77], v20 offset:4096
    ds_read_b64_tr_b16 v[78:79], v20 offset:4608
    v_fmac_f32 v15, v52, v52
    v_add_f32 v14, v14, v53
    v_fmac_f32 v15, v53, v53
    v_lshlrev_b32 v54, 16, v135
    v_and_b32 v55, 0xffff0000, v135
    v_mfma_f32_32x32x16_bf16 v[96:111], v[140:143], v[124:127], v[96:111]
    ds_read_b64_tr_b16 v[124:125], v20 offset:5120
    ds_read_b64_tr_b16 v[126:127], v20 offset:5632
    v_add_f32 v14, v14, v54
    v_fmac_f32 v15, v54, v54
    v_add_f32 v14, v14, v55
    v_fmac_f32 v15, v55, v55
    s_waitcnt vmcnt(8)
    s_waitcnt vmcnt(6)
    s_barrier
    v_add_u32 v8, 0xffff0000, v8
    ds_read_b128 v[160:163], v8 offset:0
    v_add_u32 v9, 0xffff0000, v9
    ds_read_b128 v[164:167], v9 offset:0
    v_add_u32 v10, 0xffff0000, v10
    ds_read_b128 v[168:171], v10 offset:0
    v_add_u32 v11, 0xffff0000, v11
    ds_read_b128 v[172:175], v11 offset:0
    s_waitcnt lgkmcnt(15)
    v_mfma_f32_32x32x16_bf16 v[80:95], v[144:147], v[64:67], v[80:95]
    v_add_u32 v19, 0xfffe0000, v19
    ds_read_b64_tr_b16 v[64:65], v19 offset:16384
    ds_read_b64_tr_b16 v[66:67], v19 offset:16896
    s_add_u32 m0, s50, 81920
    s_add_u32 s56, s76, 1024
    buffer_load_dwordx4 v4, s[8:11], s56 offen lds
    buffer_load_dwordx4 v4, s[8:11], s56 offen offset:1024 lds
    v_lshlrev_b32 v48, 16, v144
    v_and_b32 v49, 0xffff0000, v144
    v_add_f32 v14, v14, v48
    v_fmac_f32 v15, v48, v48
    v_mfma_f32_32x32x16_bf16 v[96:111], v[144:147], v[112:115], v[96:111]
    ds_read_b64_tr_b16 v[112:113], v19 offset:17408
    ds_read_b64_tr_b16 v[114:115], v19 offset:17920
    v_add_f32 v14, v14, v49
    v_fmac_f32 v15, v49, v49
    v_lshlrev_b32 v50, 16, v145
    v_and_b32 v51, 0xffff0000, v145
    v_add_f32 v14, v14, v50
    v_mfma_f32_32x32x16_bf16 v[80:95], v[148:151], v[68:71], v[80:95]
    ds_read_b64_tr_b16 v[68:69], v19 offset:20480
    ds_read_b64_tr_b16 v[70:71], v19 offset:20992
    v_fmac_f32 v15, v50, v50
    v_add_f32 v14, v14, v51
    v_fmac_f32 v15, v51, v51
    v_lshlrev_b32 v52, 16, v146
    v_and_b32 v53, 0xffff0000, v146
    v_mfma_f32_32x32x16_bf16 v[96:111], v[148:151], v[116:119], v[96:111]
    ds_read_b64_tr_b16 v[116:117], v19 offset:21504
    ds_read_b64_tr_b16 v[118:119], v19 offset:22016
    s_add_u32 m0, s50, 98304
    s_nop 0
    buffer_load_dwordx4 v12, s[4:7], s69 offen lds
    buffer_load_dwordx4 v13, s[4:7], s69 offen offset:1024 lds
    v_add_f32 v14, v14, v52
    v_fmac_f32 v15, v52, v52
    v_add_f32 v14, v14, v53
    v_fmac_f32 v15, v53, v53
    v_lshlrev_b32 v54, 16, v147
    s_waitcnt lgkmcnt(15)
    v_mfma_f32_16x16x32_bf16 v[40:43], v[36:39], v[56:59], v[40:43]
    v_add_u32 v21, 0xfffe0000, v21
    ds_read_b64_tr_b16 v[56:57], v21 offset:16384
    ds_read_b64_tr_b16 v[58:59], v21 offset:16896
    v_and_b32 v55, 0xffff0000, v147
    v_add_f32 v14, v14, v54
    v_fmac_f32 v15, v54, v54
    v_add_f32 v14, v14, v55
    v_fmac_f32 v15, v55, v55
    v_mfma_f32_16x16x32_bf16 v[44:47], v[36:39], v[60:63], v[44:47]
    ds_read_b64_tr_b16 v[60:61], v21 offset:17408
    ds_read_b64_tr_b16 v[62:63], v21 offset:17920
    v_lshlrev_b32 v48, 16, v148
    v_and_b32 v49, 0xffff0000, v148
    v_add_f32 v14, v14, v48
    v_fmac_f32 v15, v48, v48
    v_add_f32 v14, v14, v49
    v_mfma_f32_32x32x16_bf16 v[80:95], v[152:155], v[72:75], v[80:95]
    v_add_u32 v20, 0xfffe0000, v20
    ds_read_b64_tr_b16 v[72:73], v20 offset:16384
    ds_read_b64_tr_b16 v[74:75], v20 offset:16896
    s_add_u32 m0, s49, 147456
    s_nop 0
    buffer_load_dwordx4 v4, s[8:11], s76 offen lds
    v_fmac_f32 v15, v49, v49
    v_lshlrev_b32 v50, 16, v149
    v_and_b32 v51, 0xffff0000, v149
    v_add_f32 v14, v14, v50
    v_fmac_f32 v15, v50, v50
    v_mfma_f32_32x32x16_bf16 v[96:111], v[152:155], v[120:123], v[96:111]
    ds_read_b64_tr_b16 v[120:121], v20 offset:17408
    ds_read_b64_tr_b16 v[122:123], v20 offset:17920
    v_add_f32 v14, v14, v51
    v_fmac_f32 v15, v51, v51
    v_lshlrev_b32 v52, 16, v150
    v_and_b32 v53, 0xffff0000, v150
    v_add_f32 v14, v14, v52
    s_waitcnt lgkmcnt(15)
    v_mfma_f32_32x32x16_bf16 v[80:95], v[156:159], v[76:79], v[80:95]
    ds_read_b64_tr_b16 v[76:77], v20 offset:20480
    ds_read_b64_tr_b16 v[78:79], v20 offset:20992
    v_fmac_f32 v15, v52, v52
    v_add_f32 v14, v14, v53
    v_fmac_f32 v15, v53, v53
    v_lshlrev_b32 v54, 16, v151
    v_and_b32 v55, 0xffff0000, v151
    v_mfma_f32_32x32x16_bf16 v[96:111], v[156:159], v[124:127], v[96:111]
    ds_read_b64_tr_b16 v[124:125], v20 offset:21504
    ds_read_b64_tr_b16 v[126:127], v20 offset:22016
    v_add_f32 v14, v14, v54
    v_fmac_f32 v15, v54, v54
    v_add_f32 v14, v14, v55
    v_fmac_f32 v15, v55, v55
    s_waitcnt vmcnt(9)
    s_waitcnt vmcnt(7)
    s_barrier
    ds_read_b128 v[176:179], v8 offset:32768
    ds_read_b128 v[180:183], v9 offset:32768
    ds_read_b128 v[184:187], v10 offset:32768
    ds_read_b128 v[188:191], v11 offset:32768
    s_waitcnt lgkmcnt(15)
    v_mfma_f32_32x32x16_bf16 v[80:95], v[160:163], v[64:67], v[80:95]
    ds_read_b64_tr_b16 v[64:65], v19 offset:49152
    ds_read_b64_tr_b16 v[66:67], v19 offset:49664
    s_add_u32 m0, s50, 114688
    s_add_u32 s56, s77, 1024
    buffer_load_dwordx4 v4, s[8:11], s56 offen lds
    buffer_load_dwordx4 v4, s[8:11], s56 offen offset:1024 lds
    v_lshlrev_b32 v48, 16, v160
    v_and_b32 v49, 0xffff0000, v160
    v_add_f32 v14, v14, v48
    v_fmac_f32 v15, v48, v48
    v_mfma_f32_32x32x16_bf16 v[96:111], v[160:163], v[112:115], v[96:111]
    ds_read_b64_tr_b16 v[112:113], v19 offset:50176
    ds_read_b64_tr_b16 v[114:115], v19 offset:50688
    v_add_f32 v14, v14, v49
    v_fmac_f32 v15, v49, v49
    v_lshlrev_b32 v50, 16, v161
    v_and_b32 v51, 0xffff0000, v161
    v_add_f32 v14, v14, v50
    v_mfma_f32_32x32x16_bf16 v[80:95], v[164:167], v[68:71], v[80:95]
    ds_read_b64_tr_b16 v[68:69], v19 offset:53248
    ds_read_b64_tr_b16 v[70:71], v19 offset:53760
    v_fmac_f32 v15, v50, v50
    v_add_f32 v14, v14, v51
    v_fmac_f32 v15, v51, v51
    v_lshlrev_b32 v52, 16, v162
    v_and_b32 v53, 0xffff0000, v162
    v_mfma_f32_32x32x16_bf16 v[96:111], v[164:167], v[116:119], v[96:111]
    ds_read_b64_tr_b16 v[116:117], v19 offset:54272
    ds_read_b64_tr_b16 v[118:119], v19 offset:54784
    v_add_f32 v14, v14, v52
    v_fmac_f32 v15, v52, v52
    v_add_f32 v14, v14, v53
    v_fmac_f32 v15, v53, v53
    v_lshlrev_b32 v54, 16, v163
    s_waitcnt lgkmcnt(15)
    v_mfma_f32_16x16x32_bf16 v[40:43], v[36:39], v[56:59], v[40:43]
    ds_read_b64_tr_b16 v[56:57], v21 offset:49152
    ds_read_b64_tr_b16 v[58:59], v21 offset:49664
    v_and_b32 v55, 0xffff0000, v163
    v_add_f32 v14, v14, v54
    v_fmac_f32 v15, v54, v54
    v_add_f32 v14, v14, v55
    v_fmac_f32 v15, v55, v55
    v_mfma_f32_16x16x32_bf16 v[44:47], v[36:39], v[60:63], v[44:47]
    ds_read_b64_tr_b16 v[60:61], v21 offset:50176
    ds_read_b64_tr_b16 v[62:63], v21 offset:50688
    s_add_u32 m0, s50, 131072
    s_nop 0
    buffer_load_dwordx4 v12, s[4:7], s70 offen lds
    buffer_load_dwordx4 v13, s[4:7], s70 offen offset:1024 lds
    v_lshlrev_b32 v48, 16, v164
    v_and_b32 v49, 0xffff0000, v164
    v_add_f32 v14, v14, v48
    v_fmac_f32 v15, v48, v48
    v_add_f32 v14, v14, v49
    v_mfma_f32_32x32x16_bf16 v[80:95], v[168:171], v[72:75], v[80:95]
    ds_read_b64_tr_b16 v[72:73], v20 offset:49152
    ds_read_b64_tr_b16 v[74:75], v20 offset:49664
    v_fmac_f32 v15, v49, v49
    v_lshlrev_b32 v50, 16, v165
    v_and_b32 v51, 0xffff0000, v165
    v_add_f32 v14, v14, v50
    v_fmac_f32 v15, v50, v50
    v_mfma_f32_32x32x16_bf16 v[96:111], v[168:171], v[120:123], v[96:111]
    ds_read_b64_tr_b16 v[120:121], v20 offset:50176
    ds_read_b64_tr_b16 v[122:123], v20 offset:50688
    v_add_f32 v14, v14, v51
    v_fmac_f32 v15, v51, v51
    v_lshlrev_b32 v52, 16, v166
    v_and_b32 v53, 0xffff0000, v166
    v_add_f32 v14, v14, v52
    s_waitcnt lgkmcnt(15)
    v_mfma_f32_32x32x16_bf16 v[80:95], v[172:175], v[76:79], v[80:95]
    ds_read_b64_tr_b16 v[76:77], v20 offset:53248
    ds_read_b64_tr_b16 v[78:79], v20 offset:53760
    v_fmac_f32 v15, v52, v52
    v_add_f32 v14, v14, v53
    v_fmac_f32 v15, v53, v53
    v_lshlrev_b32 v54, 16, v167
    v_and_b32 v55, 0xffff0000, v167
    v_mfma_f32_32x32x16_bf16 v[96:111], v[172:175], v[124:127], v[96:111]
    ds_read_b64_tr_b16 v[124:125], v20 offset:54272
    ds_read_b64_tr_b16 v[126:127], v20 offset:54784
    v_add_f32 v14, v14, v54
    v_fmac_f32 v15, v54, v54
    v_add_f32 v14, v14, v55
    v_fmac_f32 v15, v55, v55
    s_waitcnt vmcnt(9)
    s_waitcnt vmcnt(7)
    s_barrier
    v_add_u32 v8, 0x10000, v8
    ds_read_b128 v[192:195], v8 offset:0
    v_add_u32 v9, 0x10000, v9
    ds_read_b128 v[196:199], v9 offset:0
    v_add_u32 v10, 0x10000, v10
    ds_read_b128 v[200:203], v10 offset:0
    v_add_u32 v11, 0x10000, v11
    ds_read_b128 v[204:207], v11 offset:0
    s_waitcnt lgkmcnt(15)
    v_mfma_f32_32x32x16_bf16 v[80:95], v[176:179], v[64:67], v[80:95]
    v_add_u32 v19, 0x10000, v19
    ds_read_b64_tr_b16 v[64:65], v19 offset:16384
    ds_read_b64_tr_b16 v[66:67], v19 offset:16896
    s_add_u32 m0, s50, 0
    s_add_u32 s56, s78, 1024
    buffer_load_dwordx4 v4, s[8:11], s56 offen lds
    buffer_load_dwordx4 v4, s[8:11], s56 offen offset:1024 lds
    v_lshlrev_b32 v48, 16, v176
    v_and_b32 v49, 0xffff0000, v176
    v_add_f32 v14, v14, v48
    v_fmac_f32 v15, v48, v48
    v_mfma_f32_32x32x16_bf16 v[96:111], v[176:179], v[112:115], v[96:111]
    ds_read_b64_tr_b16 v[112:113], v19 offset:17408
    ds_read_b64_tr_b16 v[114:115], v19 offset:17920
    v_add_f32 v14, v14, v49
    v_fmac_f32 v15, v49, v49
    v_lshlrev_b32 v50, 16, v177
    v_and_b32 v51, 0xffff0000, v177
    v_add_f32 v14, v14, v50
    v_mfma_f32_32x32x16_bf16 v[80:95], v[180:183], v[68:71], v[80:95]
    ds_read_b64_tr_b16 v[68:69], v19 offset:20480
    ds_read_b64_tr_b16 v[70:71], v19 offset:20992
    v_fmac_f32 v15, v50, v50
    v_add_f32 v14, v14, v51
    v_fmac_f32 v15, v51, v51
    v_lshlrev_b32 v52, 16, v178
    v_and_b32 v53, 0xffff0000, v178
    v_mfma_f32_32x32x16_bf16 v[96:111], v[180:183], v[116:119], v[96:111]
    ds_read_b64_tr_b16 v[116:117], v19 offset:21504
    ds_read_b64_tr_b16 v[118:119], v19 offset:22016
    v_add_f32 v14, v14, v52
    v_fmac_f32 v15, v52, v52
    v_add_f32 v14, v14, v53
    v_fmac_f32 v15, v53, v53
    v_lshlrev_b32 v54, 16, v179
    s_waitcnt lgkmcnt(15)
    v_mfma_f32_16x16x32_bf16 v[40:43], v[36:39], v[56:59], v[40:43]
    v_add_u32 v21, 0x10000, v21
    ds_read_b64_tr_b16 v[56:57], v21 offset:16384
    ds_read_b64_tr_b16 v[58:59], v21 offset:16896
    v_and_b32 v55, 0xffff0000, v179
    v_add_f32 v14, v14, v54
    v_fmac_f32 v15, v54, v54
    v_add_f32 v14, v14, v55
    v_fmac_f32 v15, v55, v55
    v_mfma_f32_16x16x32_bf16 v[44:47], v[36:39], v[60:63], v[44:47]
    ds_read_b64_tr_b16 v[60:61], v21 offset:17408
    ds_read_b64_tr_b16 v[62:63], v21 offset:17920
    s_add_u32 m0, s50, 16384
    s_nop 0
    buffer_load_dwordx4 v12, s[4:7], s71 offen lds
    buffer_load_dwordx4 v13, s[4:7], s71 offen offset:1024 lds
    v_lshlrev_b32 v48, 16, v180
    v_and_b32 v49, 0xffff0000, v180
    v_add_f32 v14, v14, v48
    v_fmac_f32 v15, v48, v48
    v_add_f32 v14, v14, v49
    v_mfma_f32_32x32x16_bf16 v[80:95], v[184:187], v[72:75], v[80:95]
    v_add_u32 v20, 0x10000, v20
    ds_read_b64_tr_b16 v[72:73], v20 offset:16384
    ds_read_b64_tr_b16 v[74:75], v20 offset:16896
    v_fmac_f32 v15, v49, v49
    v_lshlrev_b32 v50, 16, v181
    v_and_b32 v51, 0xffff0000, v181
    v_add_f32 v14, v14, v50
    v_fmac_f32 v15, v50, v50
    v_mfma_f32_32x32x16_bf16 v[96:111], v[184:187], v[120:123], v[96:111]
    ds_read_b64_tr_b16 v[120:121], v20 offset:17408
    ds_read_b64_tr_b16 v[122:123], v20 offset:17920
    v_add_f32 v14, v14, v51
    v_fmac_f32 v15, v51, v51
    v_lshlrev_b32 v52, 16, v182
    v_and_b32 v53, 0xffff0000, v182
    v_add_f32 v14, v14, v52
    s_waitcnt lgkmcnt(15)
    v_mfma_f32_32x32x16_bf16 v[80:95], v[188:191], v[76:79], v[80:95]
    ds_read_b64_tr_b16 v[76:77], v20 offset:20480
    ds_read_b64_tr_b16 v[78:79], v20 offset:20992
    v_fmac_f32 v15, v52, v52
    v_add_f32 v14, v14, v53
    v_fmac_f32 v15, v53, v53
    v_lshlrev_b32 v54, 16, v183
    v_and_b32 v55, 0xffff0000, v183
    v_mfma_f32_32x32x16_bf16 v[96:111], v[188:191], v[124:127], v[96:111]
    ds_read_b64_tr_b16 v[124:125], v20 offset:21504
    ds_read_b64_tr_b16 v[126:127], v20 offset:22016
    v_add_f32 v14, v14, v54
    v_fmac_f32 v15, v54, v54
    v_add_f32 v14, v14, v55
    v_fmac_f32 v15, v55, v55
    s_waitcnt vmcnt(9)
    s_waitcnt vmcnt(6)
    s_barrier
    ds_read_b128 v[208:211], v8 offset:32768
    ds_read_b128 v[212:215], v9 offset:32768
    ds_read_b128 v[216:219], v10 offset:32768
    ds_read_b128 v[220:223], v11 offset:32768
    v_mov_b32 v34, 0
    buffer_load_dwordx2 v[32:33], v34, s[40:43], 0 offen sc1
    s_waitcnt lgkmcnt(15)
    v_mfma_f32_32x32x16_bf16 v[80:95], v[192:195], v[64:67], v[80:95]
    ds_read_b64_tr_b16 v[64:65], v19 offset:49152
    ds_read_b64_tr_b16 v[66:67], v19 offset:49664
    s_add_u32 m0, s50, 32768
    s_add_u32 s56, s79, 1024
    buffer_load_dwordx4 v4, s[8:11], s56 offen lds
    buffer_load_dwordx4 v4, s[8:11], s56 offen offset:1024 lds
    v_lshlrev_b32 v48, 16, v192
    v_and_b32 v49, 0xffff0000, v192
    v_add_f32 v14, v14, v48
    v_fmac_f32 v15, v48, v48
    v_mfma_f32_32x32x16_bf16 v[96:111], v[192:195], v[112:115], v[96:111]
    ds_read_b64_tr_b16 v[112:113], v19 offset:50176
    ds_read_b64_tr_b16 v[114:115], v19 offset:50688
    v_add_f32 v14, v14, v49
    v_fmac_f32 v15, v49, v49
    v_lshlrev_b32 v50, 16, v193
    v_and_b32 v51, 0xffff0000, v193
    v_add_f32 v14, v14, v50
    v_mfma_f32_32x32x16_bf16 v[80:95], v[196:199], v[68:71], v[80:95]
    ds_read_b64_tr_b16 v[68:69], v19 offset:53248
    ds_read_b64_tr_b16 v[70:71], v19 offset:53760
    v_fmac_f32 v15, v50, v50
    v_add_f32 v14, v14, v51
    v_fmac_f32 v15, v51, v51
    v_lshlrev_b32 v52, 16, v194
    v_and_b32 v53, 0xffff0000, v194
    v_mfma_f32_32x32x16_bf16 v[96:111], v[196:199], v[116:119], v[96:111]
    ds_read_b64_tr_b16 v[116:117], v19 offset:54272
    ds_read_b64_tr_b16 v[118:119], v19 offset:54784
    s_add_u32 m0, s49, 49152
    s_nop 0
    buffer_load_dwordx4 v4, s[8:11], s72 offen lds
    v_add_f32 v14, v14, v52
    v_fmac_f32 v15, v52, v52
    v_add_f32 v14, v14, v53
    v_fmac_f32 v15, v53, v53
    v_lshlrev_b32 v54, 16, v195
    s_waitcnt lgkmcnt(15)
    v_mfma_f32_16x16x32_bf16 v[40:43], v[36:39], v[56:59], v[40:43]
    ds_read_b64_tr_b16 v[56:57], v21 offset:49152
    ds_read_b64_tr_b16 v[58:59], v21 offset:49664
    v_and_b32 v55, 0xffff0000, v195
    v_add_f32 v14, v14, v54
    v_fmac_f32 v15, v54, v54
    v_add_f32 v14, v14, v55
    v_fmac_f32 v15, v55, v55
    v_mfma_f32_16x16x32_bf16 v[44:47], v[36:39], v[60:63], v[44:47]
    ds_read_b64_tr_b16 v[60:61], v21 offset:50176
    ds_read_b64_tr_b16 v[62:63], v21 offset:50688
    v_lshlrev_b32 v48, 16, v196
    v_and_b32 v49, 0xffff0000, v196
    v_add_f32 v14, v14, v48
    v_fmac_f32 v15, v48, v48
    v_add_f32 v14, v14, v49
    v_mfma_f32_32x32x16_bf16 v[80:95], v[200:203], v[72:75], v[80:95]
    ds_read_b64_tr_b16 v[72:73], v20 offset:49152
    ds_read_b64_tr_b16 v[74:75], v20 offset:49664
    s_add_u32 m0, s49, 57344
    s_nop 0
    buffer_load_dwordx4 v4, s[8:11], s73 offen lds
    v_fmac_f32 v15, v49, v49
    v_lshlrev_b32 v50, 16, v197
    v_and_b32 v51, 0xffff0000, v197
    v_add_f32 v14, v14, v50
    v_fmac_f32 v15, v50, v50
    v_mfma_f32_32x32x16_bf16 v[96:111], v[200:203], v[120:123], v[96:111]
    ds_read_b64_tr_b16 v[120:121], v20 offset:50176
    ds_read_b64_tr_b16 v[122:123], v20 offset:50688
    v_add_f32 v14, v14, v51
    v_fmac_f32 v15, v51, v51
    v_lshlrev_b32 v52, 16, v198
    v_and_b32 v53, 0xffff0000, v198
    v_add_f32 v14, v14, v52
    s_waitcnt lgkmcnt(15)
    v_mfma_f32_32x32x16_bf16 v[80:95], v[204:207], v[76:79], v[80:95]
    ds_read_b64_tr_b16 v[76:77], v20 offset:53248
    ds_read_b64_tr_b16 v[78:79], v20 offset:53760
    v_fmac_f32 v15, v52, v52
    v_add_f32 v14, v14, v53
    v_fmac_f32 v15, v53, v53
    v_lshlrev_b32 v54, 16, v199
    v_and_b32 v55, 0xffff0000, v199
    v_mfma_f32_32x32x16_bf16 v[96:111], v[204:207], v[124:127], v[96:111]
    ds_read_b64_tr_b16 v[124:125], v20 offset:54272
    ds_read_b64_tr_b16 v[126:127], v20 offset:54784
    v_add_f32 v14, v14, v54
    v_fmac_f32 v15, v54, v54
    v_add_f32 v14, v14, v55
    v_fmac_f32 v15, v55, v55
    s_waitcnt vmcnt(9)
    s_waitcnt vmcnt(7)
    s_barrier
    v_add_u32 v8, 0x10000, v8
    ds_read_b128 v[224:227], v8 offset:0
    v_add_u32 v9, 0x10000, v9
    ds_read_b128 v[228:231], v9 offset:0
    v_add_u32 v10, 0x10000, v10
    ds_read_b128 v[232:235], v10 offset:0
    v_add_u32 v11, 0x10000, v11
    ds_read_b128 v[236:239], v11 offset:0
    s_waitcnt lgkmcnt(15)
    v_mfma_f32_32x32x16_bf16 v[80:95], v[208:211], v[64:67], v[80:95]
    v_add_u32 v19, 0xffff0000, v19
    ds_read_b64_tr_b16 v[64:65], v19 offset:0
    ds_read_b64_tr_b16 v[66:67], v19 offset:512
    s_add_u32 m0, s49, 65536
    s_nop 0
    buffer_load_dwordx4 v4, s[8:11], s74 offen lds
    v_lshlrev_b32 v48, 16, v208
    v_and_b32 v49, 0xffff0000, v208
    v_add_f32 v14, v14, v48
    v_fmac_f32 v15, v48, v48
    v_mfma_f32_32x32x16_bf16 v[96:111], v[208:211], v[112:115], v[96:111]
    ds_read_b64_tr_b16 v[112:113], v19 offset:1024
    ds_read_b64_tr_b16 v[114:115], v19 offset:1536
    v_add_f32 v14, v14, v49
    v_fmac_f32 v15, v49, v49
    v_lshlrev_b32 v50, 16, v209
    v_and_b32 v51, 0xffff0000, v209
    v_add_f32 v14, v14, v50
    v_mfma_f32_32x32x16_bf16 v[80:95], v[212:215], v[68:71], v[80:95]
    ds_read_b64_tr_b16 v[68:69], v19 offset:4096
    ds_read_b64_tr_b16 v[70:71], v19 offset:4608
    s_add_u32 m0, s49, 73728
    s_nop 0
    buffer_load_dwordx4 v4, s[8:11], s75 offen lds
    v_fmac_f32 v15, v50, v50
    v_add_f32 v14, v14, v51
    v_fmac_f32 v15, v51, v51
    v_lshlrev_b32 v52, 16, v210
    v_and_b32 v53, 0xffff0000, v210
    v_mfma_f32_32x32x16_bf16 v[96:111], v[212:215], v[116:119], v[96:111]
    ds_read_b64_tr_b16 v[116:117], v19 offset:5120
    ds_read_b64_tr_b16 v[118:119], v19 offset:5632
    v_add_f32 v14, v14, v52
    v_fmac_f32 v15, v52, v52
    v_add_f32 v14, v14, v53
    v_fmac_f32 v15, v53, v53
    v_lshlrev_b32 v54, 16, v211
    s_waitcnt lgkmcnt(15)
    v_mfma_f32_16x16x32_bf16 v[40:43], v[36:39], v[56:59], v[40:43]
    v_add_u32 v21, 0xffff0000, v21
    ds_read_b64_tr_b16 v[56:57], v21 offset:0
    ds_read_b64_tr_b16 v[58:59], v21 offset:512
    v_and_b32 v55, 0xffff0000, v211
    v_add_f32 v14, v14, v54
    v_fmac_f32 v15, v54, v54
    v_add_f32 v14, v14, v55
    v_fmac_f32 v15, v55, v55
    v_mfma_f32_16x16x32_bf16 v[44:47], v[36:39], v[60:63], v[44:47]
    ds_read_b64_tr_b16 v[60:61], v21 offset:1024
    ds_read_b64_tr_b16 v[62:63], v21 offset:1536
    s_add_u32 m0, s49, 81920
    s_nop 0
    buffer_load_dwordx4 v4, s[8:11], s77 offen lds
    v_lshlrev_b32 v48, 16, v212
    v_and_b32 v49, 0xffff0000, v212
    v_add_f32 v14, v14, v48
    v_fmac_f32 v15, v48, v48
    v_add_f32 v14, v14, v49
    v_mfma_f32_32x32x16_bf16 v[80:95], v[216:219], v[72:75], v[80:95]
    v_add_u32 v20, 0xffff0000, v20
    ds_read_b64_tr_b16 v[72:73], v20 offset:0
    ds_read_b64_tr_b16 v[74:75], v20 offset:512
    v_fmac_f32 v15, v49, v49
    v_lshlrev_b32 v50, 16, v213
    v_and_b32 v51, 0xffff0000, v213
    v_add_f32 v14, v14, v50
    v_fmac_f32 v15, v50, v50
    v_mfma_f32_32x32x16_bf16 v[96:111], v[216:219], v[120:123], v[96:111]
    ds_read_b64_tr_b16 v[120:121], v20 offset:1024
    ds_read_b64_tr_b16 v[122:123], v20 offset:1536
    s_add_u32 m0, s49, 90112
    s_nop 0
    buffer_load_dwordx4 v4, s[8:11], s78 offen lds
    v_add_f32 v14, v14, v51
    v_fmac_f32 v15, v51, v51
    v_lshlrev_b32 v52, 16, v214
    v_and_b32 v53, 0xffff0000, v214
    v_add_f32 v14, v14, v52
    s_waitcnt lgkmcnt(15)
    v_mfma_f32_32x32x16_bf16 v[80:95], v[220:223], v[76:79], v[80:95]
    ds_read_b64_tr_b16 v[76:77], v20 offset:4096
    ds_read_b64_tr_b16 v[78:79], v20 offset:4608
    v_fmac_f32 v15, v52, v52
    v_add_f32 v14, v14, v53
    v_fmac_f32 v15, v53, v53
    v_lshlrev_b32 v54, 16, v215
    v_and_b32 v55, 0xffff0000, v215
    v_mfma_f32_32x32x16_bf16 v[96:111], v[220:223], v[124:127], v[96:111]
    ds_read_b64_tr_b16 v[124:125], v20 offset:5120
    ds_read_b64_tr_b16 v[126:127], v20 offset:5632
    v_add_f32 v14, v14, v54
    v_fmac_f32 v15, v54, v54
    v_add_f32 v14, v14, v55
    v_fmac_f32 v15, v55, v55
    s_waitcnt vmcnt(9)
    s_waitcnt vmcnt(6)
    s_barrier
    v_add_u32 v8, 0xfffe0000, v8
    ds_read_b128 v[240:243], v8 offset:16384
    v_add_u32 v9, 0xfffe0000, v9
    ds_read_b128 v[244:247], v9 offset:16384
    v_add_u32 v10, 0xfffe0000, v10
    ds_read_b128 v[248:251], v10 offset:16384
    v_add_u32 v11, 0xfffe0000, v11
    ds_read_b128 v[252:255], v11 offset:16384
    s_waitcnt lgkmcnt(15)
    v_mfma_f32_32x32x16_bf16 v[80:95], v[224:227], v[64:67], v[80:95]
    ds_read_b64_tr_b16 v[64:65], v19 offset:32768
    ds_read_b64_tr_b16 v[66:67], v19 offset:33280
    s_add_u32 m0, s49, 98304
    s_nop 0
    buffer_load_dwordx4 v4, s[8:11], s79 offen lds
    v_lshlrev_b32 v48, 16, v224
    v_and_b32 v49, 0xffff0000, v224
    v_add_f32 v14, v14, v48
    v_fmac_f32 v15, v48, v48
    v_mfma_f32_32x32x16_bf16 v[96:111], v[224:227], v[112:115], v[96:111]
    ds_read_b64_tr_b16 v[112:113], v19 offset:33792
    ds_read_b64_tr_b16 v[114:115], v19 offset:34304
    v_add_f32 v14, v14, v49
    v_fmac_f32 v15, v49, v49
    v_lshlrev_b32 v50, 16, v225
    v_and_b32 v51, 0xffff0000, v225
    v_add_f32 v14, v14, v50
    v_mfma_f32_32x32x16_bf16 v[80:95], v[228:231], v[68:71], v[80:95]
    ds_read_b64_tr_b16 v[68:69], v19 offset:36864
    ds_read_b64_tr_b16 v[70:71], v19 offset:37376
    v_fmac_f32 v15, v50, v50
    v_add_f32 v14, v14, v51
    v_fmac_f32 v15, v51, v51
    v_lshlrev_b32 v52, 16, v226
    v_and_b32 v53, 0xffff0000, v226
    v_mfma_f32_32x32x16_bf16 v[96:111], v[228:231], v[116:119], v[96:111]
    ds_read_b64_tr_b16 v[116:117], v19 offset:37888
    ds_read_b64_tr_b16 v[118:119], v19 offset:38400
    s_add_u32 m0, s49, 114688
    s_add_u32 s56, s63, s46
    s_add_u32 s56, s56, 0
    s_and_b32 s56, s56, 7
    s_mul_i32 s56, s56, 229376
    s_add_u32 s56, s56, s53
    buffer_load_dwordx4 v5, s[12:15], s56 offen lds
    v_add_f32 v14, v14, v52
    v_fmac_f32 v15, v52, v52
    v_add_f32 v14, v14, v53
    v_fmac_f32 v15, v53, v53
    v_lshlrev_b32 v54, 16, v227
    s_waitcnt lgkmcnt(15)
    v_mfma_f32_16x16x32_bf16 v[40:43], v[36:39], v[56:59], v[40:43]
    ds_read_b64_tr_b16 v[56:57], v21 offset:32768
    ds_read_b64_tr_b16 v[58:59], v21 offset:33280
    v_and_b32 v55, 0xffff0000, v227
    v_add_f32 v14, v14, v54
    v_fmac_f32 v15, v54, v54
    v_add_f32 v14, v14, v55
    v_fmac_f32 v15, v55, v55
    v_mfma_f32_16x16x32_bf16 v[44:47], v[36:39], v[60:63], v[44:47]
    ds_read_b64_tr_b16 v[60:61], v21 offset:33792
    ds_read_b64_tr_b16 v[62:63], v21 offset:34304
    v_lshlrev_b32 v48, 16, v228
    v_and_b32 v49, 0xffff0000, v228
    v_add_f32 v14, v14, v48
    v_fmac_f32 v15, v48, v48
    v_add_f32 v14, v14, v49
    v_mfma_f32_32x32x16_bf16 v[80:95], v[232:235], v[72:75], v[80:95]
    ds_read_b64_tr_b16 v[72:73], v20 offset:32768
    ds_read_b64_tr_b16 v[74:75], v20 offset:33280
    s_add_u32 m0, s49, 122880
    s_add_u32 s56, s63, s46
    s_add_u32 s56, s56, 2
    s_and_b32 s56, s56, 7
    s_mul_i32 s56, s56, 229376
    s_add_u32 s56, s56, s53
    buffer_load_dwordx4 v5, s[12:15], s56 offen lds
    v_fmac_f32 v15, v49, v49
    v_lshlrev_b32 v50, 16, v229
    v_and_b32 v51, 0xffff0000, v229
    v_add_f32 v14, v14, v50
    v_fmac_f32 v15, v50, v50
    v_mfma_f32_32x32x16_bf16 v[96:111], v[232:235], v[120:123], v[96:111]
    ds_read_b64_tr_b16 v[120:121], v20 offset:33792
    ds_read_b64_tr_b16 v[122:123], v20 offset:34304
    v_add_f32 v14, v14, v51
    v_fmac_f32 v15, v51, v51
    v_lshlrev_b32 v52, 16, v230
    v_and_b32 v53, 0xffff0000, v230
    v_add_f32 v14, v14, v52
    s_waitcnt lgkmcnt(15)
    v_mfma_f32_32x32x16_bf16 v[80:95], v[236:239], v[76:79], v[80:95]
    ds_read_b64_tr_b16 v[76:77], v20 offset:36864
    ds_read_b64_tr_b16 v[78:79], v20 offset:37376
    v_fmac_f32 v15, v52, v52
    v_add_f32 v14, v14, v53
    v_fmac_f32 v15, v53, v53
    v_lshlrev_b32 v54, 16, v231
    v_and_b32 v55, 0xffff0000, v231
    v_mfma_f32_32x32x16_bf16 v[96:111], v[236:239], v[124:127], v[96:111]
    ds_read_b64_tr_b16 v[124:125], v20 offset:37888
    ds_read_b64_tr_b16 v[126:127], v20 offset:38400
    v_add_f32 v14, v14, v54
    v_fmac_f32 v15, v54, v54
    v_add_f32 v14, v14, v55
    v_fmac_f32 v15, v55, v55
    s_waitcnt lgkmcnt(15)
    v_mfma_f32_32x32x16_bf16 v[80:95], v[240:243], v[64:67], v[80:95]
    v_lshlrev_b32 v48, 16, v240
    v_and_b32 v49, 0xffff0000, v240
    v_add_f32 v14, v14, v48
    v_fmac_f32 v15, v48, v48
    v_mfma_f32_32x32x16_bf16 v[96:111], v[240:243], v[112:115], v[96:111]
    v_add_f32 v14, v14, v49
    v_fmac_f32 v15, v49, v49
    v_lshlrev_b32 v50, 16, v241
    v_and_b32 v51, 0xffff0000, v241
    v_add_f32 v14, v14, v50
    s_waitcnt lgkmcnt(14)
    v_mfma_f32_32x32x16_bf16 v[80:95], v[244:247], v[68:71], v[80:95]
    v_fmac_f32 v15, v50, v50
    v_add_f32 v14, v14, v51
    v_fmac_f32 v15, v51, v51
    v_lshlrev_b32 v52, 16, v242
    v_and_b32 v53, 0xffff0000, v242
    s_waitcnt lgkmcnt(12)
    v_mfma_f32_32x32x16_bf16 v[96:111], v[244:247], v[116:119], v[96:111]
    v_add_f32 v14, v14, v52
    v_fmac_f32 v15, v52, v52
    v_add_f32 v14, v14, v53
    v_fmac_f32 v15, v53, v53
    v_lshlrev_b32 v54, 16, v243
    s_waitcnt lgkmcnt(10)
    v_mfma_f32_16x16x32_bf16 v[40:43], v[36:39], v[56:59], v[40:43]
    v_and_b32 v55, 0xffff0000, v243
    v_add_f32 v14, v14, v54
    v_fmac_f32 v15, v54, v54
    v_add_f32 v14, v14, v55
    v_fmac_f32 v15, v55, v55
    s_waitcnt lgkmcnt(8)
    v_mfma_f32_16x16x32_bf16 v[44:47], v[36:39], v[60:63], v[44:47]
    v_lshlrev_b32 v48, 16, v244
    v_and_b32 v49, 0xffff0000, v244
    v_add_f32 v14, v14, v48
    v_fmac_f32 v15, v48, v48
    v_add_f32 v14, v14, v49
    s_waitcnt lgkmcnt(6)
    v_mfma_f32_32x32x16_bf16 v[80:95], v[248:251], v[72:75], v[80:95]
    v_fmac_f32 v15, v49, v49
    v_lshlrev_b32 v50, 16, v245
    v_and_b32 v51, 0xffff0000, v245
    v_add_f32 v14, v14, v50
    v_fmac_f32 v15, v50, v50
    s_waitcnt lgkmcnt(4)
    v_mfma_f32_32x32x16_bf16 v[96:111], v[248:251], v[120:123], v[96:111]
    v_add_f32 v14, v14, v51
    v_fmac_f32 v15, v51, v51
    v_lshlrev_b32 v52, 16, v246
    v_and_b32 v53, 0xffff0000, v246
    v_add_f32 v14, v14, v52
    s_waitcnt lgkmcnt(2)
    v_mfma_f32_32x32x16_bf16 v[80:95], v[252:255], v[76:79], v[80:95]
    v_fmac_f32 v15, v52, v52
    v_add_f32 v14, v14, v53
    v_fmac_f32 v15, v53, v53
    v_lshlrev_b32 v54, 16, v247
    v_and_b32 v55, 0xffff0000, v247
    s_waitcnt lgkmcnt(0)
    v_mfma_f32_32x32x16_bf16 v[96:111], v[252:255], v[124:127], v[96:111]
    v_add_f32 v14, v14, v54
    v_fmac_f32 v15, v54, v54
    v_add_f32 v14, v14, v55
    v_fmac_f32 v15, v55, v55
    s_lshr_b32 s56, s2, 3
    s_lshl_b32 s56, s56, 3
    s_add_u32 s56, s56, s44
    s_mul_i32 s57, s56, 7168
    s_lshl_b32 s56, s56, 11
    v_min_u32 v28, 55, v1
    v_lshlrev_b32 v28, 7, v28
    buffer_load_dword v28, v28, s[20:23], s57 offen
    v_and_b32 v29, 15, v1
    v_lshlrev_b32 v29, 7, v29
    buffer_load_dword v29, v29, s[24:27], s56 offen
    v_and_b32 v48, 31, v1
    v_lshlrev_b32 v48, 5, v48
    s_lshl_b32 s56, s45, 10
    s_add_u32 s56, s56, 155648
    v_add_u32 v48, s56, v48
    v_lshrrev_b32 v49, 5, v1
    v_lshl_add_u32 v49, v49, 3, v48
    s_lshl_b32 s56, s46, 4
    v_add_u32 v49, s56, v49
    ds_write_b64 v49, v[14:15]
    s_mov_b32 exec_hi, 0
    ds_write_b32 v30, v40 offset:0
    s_mov_b32 exec_hi, -1
    s_mov_b32 exec_hi, 0
    ds_write_b32 v30, v44 offset:1024
    s_mov_b32 exec_hi, -1
    s_mov_b32 s57, 8000
L_np1:
    v_readfirstlane_b32 s56, v32
    s_nop 0
    s_cmp_lg_u32 s56, 0
    s_cbranch_scc1 L_np1x
    s_sleep 2
    buffer_load_dwordx2 v[32:33], v34, s[40:43], 0 offen sc1
    s_waitcnt vmcnt(0)
    s_sub_u32 s57, s57, 1
    s_cmp_lg_u32 s57, 0
    s_cbranch_scc1 L_np1
L_np1x:
    v_readfirstlane_b32 s94, v32
    v_readfirstlane_b32 s95, v33
    s_waitcnt lgkmcnt(0)
    s_waitcnt vmcnt(10)
    s_waitcnt vmcnt(9)
    s_waitcnt vmcnt(8)
    s_waitcnt vmcnt(7)
    s_waitcnt vmcnt(6)
    s_waitcnt vmcnt(5)
    s_waitcnt vmcnt(4)
    s_barrier
    ds_read_b128 v[50:53], v48
    ds_read_b128 v[54:57], v48 offset:16
    s_waitcnt lgkmcnt(0)
    v_add_f32 v50, v50, v52
    v_add_f32 v54, v54, v56
    v_add_f32 v51, v51, v53
    v_add_f32 v55, v55, v57
    v_add_f32 v50, v50, v54
    v_add_f32 v51, v51, v55
    v_mul_f32 v50, 0xbb000000, v50
    v_mul_f32 v51, 0x3b000000, v51
    v_fma_f32 v51, -v50, v50, v51
    v_max_f32 v51, 0, v51
    v_add_f32 v51, 0x3727c5ac, v51
    v_sqrt_f32 v24, v51
    s_nop 0
    v_rcp_f32 v55, v24
    s_nop 0
    v_mul_f32 v26, 0x3fb8aa3b, v55
    v_mul_f32 v22, 0xc0135761, v55
    v_mul_f32 v23, v55, v55
    v_mul_f32 v23, v23, v55
    v_mul_f32 v23, 0xbdd2d3e8, v23
    v_cvt_pk_bf16_f32 v52, v50, v24
    v_lshlrev_b32 v53, 16, v52
    v_and_b32 v54, 0xffff0000, v52
    v_sub_f32 v55, v50, v53
    v_sub_f32 v56, v24, v54
    v_cvt_pk_bf16_f32 v55, v53, v55
    v_cvt_pk_bf16_f32 v56, v56, 0
    v_cmp_gt_u32 vcc, 32, v1
    s_nop 1
    v_cndmask_b32 v32, 0, v55, vcc
    v_cndmask_b32 v33, 0, v52, vcc
    v_cndmask_b32 v34, 0, v56, vcc
    v_mov_b32 v35, 0
    v_and_b32 v50, 31, v1
    v_lshlrev_b32 v50, 2, v50
    s_lshl_b32 s56, s45, 7
    s_add_u32 s56, s56, 162816
    v_add_u32 v50, s56, v50
    ds_write_b32 v50, v26
    ds_read_b64_tr_b16 v[64:65], v16 offset:49152
    ds_read_b64_tr_b16 v[66:67], v16 offset:49664
    ds_read_b64_tr_b16 v[68:69], v16 offset:51200
    ds_read_b64_tr_b16 v[70:71], v16 offset:51712
    ds_read_b64_tr_b16 v[72:73], v17 offset:49152
    ds_read_b64_tr_b16 v[74:75], v17 offset:49664
    ds_read_b64_tr_b16 v[76:77], v17 offset:51200
    ds_read_b64_tr_b16 v[78:79], v17 offset:51712
    ds_read_b64_tr_b16 v[44:45], v18 offset:49152
    ds_read_b64_tr_b16 v[46:47], v18 offset:49664
    v_lshrrev_b32 v21, 5, v1
    v_lshlrev_b32 v21, 4, v21
    s_lshl_b32 s58, s45, 7
    s_add_u32 s58, s58, 162816
    v_add_u32 v21, s58, v21
    ds_read_b128 v[8:11], v21 offset:0
    ds_read_b128 v[12:15], v21 offset:32
    v_mov_b32 v19, 0x3f317218
    ds_read_b128 v[48:51], v31 offset:0
    s_add_u32 m0, s49, 131072
    s_add_u32 s56, s63, s46
    s_add_u32 s56, s56, 4
    s_and_b32 s56, s56, 7
    s_mul_i32 s56, s56, 229376
    s_add_u32 s56, s56, s53
    buffer_load_dwordx4 v5, s[12:15], s56 offen lds
    s_waitcnt lgkmcnt(11)
    v_mfma_f32_32x32x16_bf16 v[112:127], v[64:67], v[128:131], 0
    ds_read_b64_tr_b16 v[64:65], v16 offset:57344
    ds_read_b64_tr_b16 v[66:67], v16 offset:57856
    s_waitcnt lgkmcnt(2)
    v_add_f32 v48, v48, v49
    v_add_f32 v50, v50, v51
    v_add_f32 v48, v48, v50
    v_mfma_f32_32x32x16_bf16 v[112:127], v[68:71], v[132:135], v[112:127]
    ds_read_b64_tr_b16 v[68:69], v16 offset:59392
    ds_read_b64_tr_b16 v[70:71], v16 offset:59904
    v_cvt_pk_bf16_f32 v52, v48, v48
    v_lshlrev_b32 v49, 16, v52
    v_sub_f32 v48, v48, v49
    v_cvt_pk_bf16_f32 v53, v48, 0
    v_mov_b32 v54, 0
    v_mov_b32 v55, 0
    s_nop 1
    v_mfma_f32_32x32x16_bf16 v[80:95], v[32:35], v[52:55], v[80:95]
    v_mfma_f32_32x32x16_bf16 v[112:127], v[72:75], v[136:139], v[112:127]
    ds_read_b64_tr_b16 v[72:73], v17 offset:57344
    ds_read_b64_tr_b16 v[74:75], v17 offset:57856
    v_mfma_f32_16x16x32_bf16 v[40:43], v[36:39], v[44:47], 0
    ds_read_b64_tr_b16 v[44:45], v18 offset:57344
    ds_read_b64_tr_b16 v[46:47], v18 offset:57856
    ds_read_b128 v[48:51], v31 offset:1024
    v_mfma_f32_32x32x16_bf16 v[112:127], v[76:79], v[140:143], v[112:127]
    ds_read_b64_tr_b16 v[76:77], v17 offset:59392
    ds_read_b64_tr_b16 v[78:79], v17 offset:59904
    s_waitcnt lgkmcnt(2)
    v_add_f32 v48, v48, v49
    v_add_f32 v50, v50, v51
    v_add_f32 v48, v48, v50
    v_cvt_pk_bf16_f32 v52, v48, v48
    v_lshlrev_b32 v49, 16, v52
    v_sub_f32 v48, v48, v49
    v_cvt_pk_bf16_f32 v53, v48, 0
    v_mfma_f32_32x32x16_bf16 v[112:127], v[64:67], v[144:147], v[112:127]
    v_add_u32 v16, 0x10000, v16
    ds_read_b64_tr_b16 v[64:65], v16 offset:0
    ds_read_b64_tr_b16 v[66:67], v16 offset:512
    v_mov_b32 v54, 0
    v_mov_b32 v55, 0
    s_nop 1
    v_mfma_f32_32x32x16_bf16 v[96:111], v[32:35], v[52:55], v[96:111]
    v_mfma_f32_32x32x16_bf16 v[112:127], v[68:71], v[148:151], v[112:127]
    ds_read_b64_tr_b16 v[68:69], v16 offset:2048
    ds_read_b64_tr_b16 v[70:71], v16 offset:2560
    v_mul_f32 v80, v80, v8
    s_add_u32 m0, s49, 139264
    s_add_u32 s56, s63, s46
    s_add_u32 s56, s56, 6
    s_and_b32 s56, s56, 7
    s_mul_i32 s56, s56, 229376
    s_add_u32 s56, s56, s53
    buffer_load_dwordx4 v5, s[12:15], s56 offen lds
    v_mfma_f32_32x32x16_bf16 v[112:127], v[72:75], v[152:155], v[112:127]
    v_add_u32 v17, 0x10000, v17
    ds_read_b64_tr_b16 v[72:73], v17 offset:0
    ds_read_b64_tr_b16 v[74:75], v17 offset:512
    v_mul_f32 v96, v96, v8
    v_exp_f32 v56, v80 clamp
    v_mul_f32 v81, v81, v9
    v_mul_f32 v97, v97, v9
    v_max_f32 v80, 0, v80
    v_exp_f32 v57, v81 clamp
    v_mfma_f32_16x16x32_bf16 v[40:43], v[36:39], v[44:47], v[40:43]
    v_add_u32 v18, 0x10000, v18
    ds_read_b64_tr_b16 v[44:45], v18 offset:0
    ds_read_b64_tr_b16 v[46:47], v18 offset:512
    v_mul_f32 v82, v82, v10
    v_mul_f32 v98, v98, v10
    v_fmaak_f32 v80, v80, v19, 0x358637bd
    v_max_f32 v81, 0, v81
    v_exp_f32 v58, v82 clamp
    v_mul_f32 v83, v83, v11
    v_mul_f32 v99, v99, v11
    s_waitcnt lgkmcnt(8)
    v_mfma_f32_32x32x16_bf16 v[112:127], v[76:79], v[156:159], v[112:127]
    ds_read_b64_tr_b16 v[76:77], v17 offset:2048
    ds_read_b64_tr_b16 v[78:79], v17 offset:2560
    v_add_f32 v80, v80, v56
    v_fmaak_f32 v81, v81, v19, 0x358637bd
    v_max_f32 v82, 0, v82
    ds_read_b128 v[8:11], v21 offset:64
    v_exp_f32 v59, v83 clamp
    v_mul_f32 v84, v84, v12
    v_mul_f32 v100, v100, v12
    v_add_f32 v81, v81, v57
    s_waitcnt lgkmcnt(9)
    v_mfma_f32_32x32x16_bf16 v[112:127], v[64:67], v[160:163], v[112:127]
    ds_read_b64_tr_b16 v[64:65], v16 offset:8192
    ds_read_b64_tr_b16 v[66:67], v16 offset:8704
    v_fmaak_f32 v82, v82, v19, 0x358637bd
    v_max_f32 v83, 0, v83
    v_exp_f32 v60, v84 clamp
    v_mul_f32 v85, v85, v13
    v_mul_f32 v101, v101, v13
    v_cvt_pk_bf16_f32 v48, v80, v81
    v_add_f32 v82, v82, v58
    s_waitcnt lgkmcnt(9)
    v_mfma_f32_32x32x16_bf16 v[112:127], v[68:71], v[164:167], v[112:127]
    ds_read_b64_tr_b16 v[68:69], v16 offset:10240
    ds_read_b64_tr_b16 v[70:71], v16 offset:10752
    v_fmaak_f32 v83, v83, v19, 0x358637bd
    v_max_f32 v84, 0, v84
    v_exp_f32 v61, v85 clamp
    v_mul_f32 v86, v86, v14
    v_mul_f32 v102, v102, v14
    v_add_f32 v83, v83, v59
    v_fmaak_f32 v84, v84, v19, 0x358637bd
    v_max_f32 v85, 0, v85
    s_waitcnt lgkmcnt(9)
    v_mfma_f32_32x32x16_bf16 v[112:127], v[72:75], v[168:171], v[112:127]
    ds_read_b64_tr_b16 v[72:73], v17 offset:8192
    ds_read_b64_tr_b16 v[74:75], v17 offset:8704
    v_exp_f32 v62, v86 clamp
    v_mul_f32 v87, v87, v15
    v_mul_f32 v103, v103, v15
    v_cvt_pk_bf16_f32 v49, v82, v83
    v_add_f32 v84, v84, v60
    v_fmaak_f32 v85, v85, v19, 0x358637bd
    v_max_f32 v86, 0, v86
    s_waitcnt lgkmcnt(9)
    v_mfma_f32_16x16x32_bf16 v[40:43], v[36:39], v[44:47], v[40:43]
    ds_read_b64_tr_b16 v[44:45], v18 offset:8192
    ds_read_b64_tr_b16 v[46:47], v18 offset:8704
    ds_read_b128 v[12:15], v21 offset:96
    v_exp_f32 v63, v87 clamp
    s_waitcnt lgkmcnt(9)
    v_mul_f32 v88, v88, v8
    v_mul_f32 v104, v104, v8
    v_add_f32 v85, v85, v61
    v_fmaak_f32 v86, v86, v19, 0x358637bd
    v_max_f32 v87, 0, v87
    v_mfma_f32_32x32x16_bf16 v[112:127], v[76:79], v[172:175], v[112:127]
    ds_read_b64_tr_b16 v[76:77], v17 offset:10240
    ds_read_b64_tr_b16 v[78:79], v17 offset:10752
    v_exp_f32 v56, v88 clamp
    v_mul_f32 v89, v89, v9
    v_mul_f32 v105, v105, v9
    v_cvt_pk_bf16_f32 v50, v84, v85
    v_add_f32 v86, v86, v62
    v_fmaak_f32 v87, v87, v19, 0x358637bd
    v_max_f32 v88, 0, v88
    v_exp_f32 v57, v89 clamp
    s_add_u32 m0, s50, 0
    s_mul_i32 s56, s44, 196608
    s_add_u32 s56, s56, s62
    s_add_u32 s56, s56, 0
    buffer_load_dwordx4 v7, s[20:23], s56 offen lds
    buffer_load_dwordx4 v0, s[20:23], s56 offen offset:1024 lds
    s_waitcnt lgkmcnt(9)
    v_mfma_f32_32x32x16_bf16 v[112:127], v[64:67], v[176:179], v[112:127]
    v_add_u32 v16, 0x10000, v16
    ds_read_b64_tr_b16 v[64:65], v16 offset:16384
    ds_read_b64_tr_b16 v[66:67], v16 offset:16896
    v_mul_f32 v90, v90, v10
    v_mul_f32 v106, v106, v10
    v_add_f32 v87, v87, v63
    v_fmaak_f32 v88, v88, v19, 0x358637bd
    v_max_f32 v89, 0, v89
    v_exp_f32 v58, v90 clamp
    s_waitcnt lgkmcnt(9)
    v_mfma_f32_32x32x16_bf16 v[112:127], v[68:71], v[180:183], v[112:127]
    ds_read_b64_tr_b16 v[68:69], v16 offset:18432
    ds_read_b64_tr_b16 v[70:71], v16 offset:18944
    v_mul_f32 v91, v91, v11
    v_mul_f32 v107, v107, v11
    v_cvt_pk_bf16_f32 v51, v86, v87
    v_add_f32 v88, v88, v56
    v_fmaak_f32 v89, v89, v19, 0x358637bd
    v_max_f32 v90, 0, v90
    v_exp_f32 v59, v91 clamp
    s_waitcnt lgkmcnt(6)
    v_mfma_f32_32x32x16_bf16 v[112:127], v[72:75], v[184:187], v[112:127]
    v_add_u32 v17, 0x10000, v17
    ds_read_b64_tr_b16 v[72:73], v17 offset:16384
    ds_read_b64_tr_b16 v[74:75], v17 offset:16896
    v_mul_f32 v92, v92, v12
    v_mul_f32 v108, v108, v12
    v_add_f32 v89, v89, v57
    v_fmaak_f32 v90, v90, v19, 0x358637bd
    v_max_f32 v91, 0, v91
    v_exp_f32 v60, v92 clamp
    v_mul_f32 v93, v93, v13
    v_mfma_f32_16x16x32_bf16 v[40:43], v[36:39], v[44:47], v[40:43]
    v_add_u32 v18, 0x10000, v18
    ds_read_b64_tr_b16 v[44:45], v18 offset:16384
    ds_read_b64_tr_b16 v[46:47], v18 offset:16896
    v_mul_f32 v109, v109, v13
    v_cvt_pk_bf16_f32 v52, v88, v89
    v_add_f32 v90, v90, v58
    v_fmaak_f32 v91, v91, v19, 0x358637bd
    v_max_f32 v92, 0, v92
    v_exp_f32 v61, v93 clamp
    v_mul_f32 v94, v94, v14
    s_waitcnt lgkmcnt(8)
    v_mfma_f32_32x32x16_bf16 v[112:127], v[76:79], v[188:191], v[112:127]
    ds_read_b64_tr_b16 v[76:77], v17 offset:18432
    ds_read_b64_tr_b16 v[78:79], v17 offset:18944
    v_mul_f32 v110, v110, v14
    v_add_f32 v91, v91, v59
    v_fmaak_f32 v92, v92, v19, 0x358637bd
    v_max_f32 v93, 0, v93
    v_exp_f32 v62, v94 clamp
    v_mul_f32 v95, v95, v15
    v_mul_f32 v111, v111, v15
    v_cvt_pk_bf16_f32 v53, v90, v91
    s_waitcnt lgkmcnt(8)
    v_mfma_f32_32x32x16_bf16 v[112:127], v[64:67], v[192:195], v[112:127]
    v_add_u32 v16, 0xffff0000, v16
    ds_read_b64_tr_b16 v[64:65], v16 offset:16384
    ds_read_b64_tr_b16 v[66:67], v16 offset:16896
    v_add_f32 v92, v92, v60
    v_fmaak_f32 v93, v93, v19, 0x358637bd
    v_max_f32 v94, 0, v94
    v_exp_f32 v63, v95 clamp
    v_add_f32 v93, v93, v61
    v_fmaak_f32 v94, v94, v19, 0x358637bd
    v_max_f32 v95, 0, v95
    s_waitcnt lgkmcnt(8)
    v_mfma_f32_32x32x16_bf16 v[112:127], v[68:71], v[196:199], v[112:127]
    ds_read_b64_tr_b16 v[68:69], v16 offset:18432
    ds_read_b64_tr_b16 v[70:71], v16 offset:18944
    v_cvt_pk_bf16_f32 v54, v92, v93
    v_add_f32 v94, v94, v62
    v_fmaak_f32 v95, v95, v19, 0x358637bd
    v_add_f32 v95, v95, v63
    v_cvt_pk_bf16_f32 v55, v94, v95
    v_cvt_pk_bf16_f32 v96, v96, v97
    v_cvt_pk_bf16_f32 v97, v98, v99
    v_cvt_pk_bf16_f32 v98, v100, v101
    v_cvt_pk_bf16_f32 v99, v102, v103
    s_add_u32 m0, s50, 16384
    s_mul_i32 s56, s44, 196608
    s_add_u32 s56, s56, s62
    s_add_u32 s56, s56, 16384
    buffer_load_dwordx4 v7, s[20:23], s56 offen lds
    buffer_load_dwordx4 v0, s[20:23], s56 offen offset:1024 lds
    s_waitcnt lgkmcnt(8)
    v_mfma_f32_32x32x16_bf16 v[112:127], v[72:75], v[200:203], v[112:127]
    v_add_u32 v17, 0xffff0000, v17
    ds_read_b64_tr_b16 v[72:73], v17 offset:16384
    ds_read_b64_tr_b16 v[74:75], v17 offset:16896
    v_cvt_pk_bf16_f32 v100, v104, v105
    v_cvt_pk_bf16_f32 v101, v106, v107
    v_cvt_pk_bf16_f32 v102, v108, v109
    v_cvt_pk_bf16_f32 v103, v110, v111
    v_and_b32 v21, 16, v1
    v_cmp_eq_u32 vcc, 0, v21
    v_lshrrev_b32 v21, 3, v1
    v_lshlrev_b32 v21, 13, v21
    s_waitcnt lgkmcnt(8)
    v_mfma_f32_16x16x32_bf16 v[40:43], v[36:39], v[44:47], v[40:43]
    v_add_u32 v18, 0xffff0000, v18
    ds_read_b64_tr_b16 v[44:45], v18 offset:16384
    ds_read_b64_tr_b16 v[46:47], v18 offset:16896
    v_and_b32 v104, 112, v6
    v_add_u32 v21, v21, v104
    v_mov_b32 v104, 0x3f803f80
    v_cndmask_b32 v56, v104, v96, vcc
    v_cndmask_b32 v57, v104, v97, vcc
    v_cndmask_b32 v58, v104, v98, vcc
    v_cndmask_b32 v59, v104, v99, vcc
    v_cndmask_b32 v60, v104, v100, vcc
    s_waitcnt lgkmcnt(8)
    v_mfma_f32_32x32x16_bf16 v[112:127], v[76:79], v[204:207], v[112:127]
    ds_read_b64_tr_b16 v[76:77], v17 offset:18432
    ds_read_b64_tr_b16 v[78:79], v17 offset:18944
    v_cndmask_b32 v61, v104, v101, vcc
    v_cndmask_b32 v62, v104, v102, vcc
    v_cndmask_b32 v63, v104, v103, vcc
    v_cndmask_b32 v8, v96, v104, vcc
    v_cndmask_b32 v9, v97, v104, vcc
    v_cndmask_b32 v10, v98, v104, vcc
    v_cndmask_b32 v11, v99, v104, vcc
    v_cndmask_b32 v12, v100, v104, vcc
    v_cndmask_b32 v13, v101, v104, vcc
    s_waitcnt lgkmcnt(8)
    v_mfma_f32_32x32x16_bf16 v[112:127], v[64:67], v[208:211], v[112:127]
    ds_read_b64_tr_b16 v[64:65], v16 offset:24576
    ds_read_b64_tr_b16 v[66:67], v16 offset:25088
    v_cndmask_b32 v14, v102, v104, vcc
    v_cndmask_b32 v15, v103, v104, vcc
    v_mfma_f32_32x32x16_bf16 v[80:95], v[48:51], v[56:59], 0
    s_waitcnt lgkmcnt(8)
    v_mfma_f32_32x32x16_bf16 v[112:127], v[68:71], v[212:215], v[112:127]
    ds_read_b64_tr_b16 v[68:69], v16 offset:26624
    ds_read_b64_tr_b16 v[70:71], v16 offset:27136
    v_mfma_f32_32x32x16_bf16 v[96:111], v[48:51], v[8:11], 0
    v_mfma_f32_32x32x16_bf16 v[80:95], v[52:55], v[60:63], v[80:95]
    s_waitcnt lgkmcnt(8)
    v_mfma_f32_32x32x16_bf16 v[112:127], v[72:75], v[216:219], v[112:127]
    ds_read_b64_tr_b16 v[72:73], v17 offset:24576
    ds_read_b64_tr_b16 v[74:75], v17 offset:25088
    v_mfma_f32_32x32x16_bf16 v[96:111], v[52:55], v[12:15], v[96:111]
    s_waitcnt lgkmcnt(8)
    v_mfma_f32_16x16x32_bf16 v[40:43], v[36:39], v[44:47], v[40:43]
    ds_read_b64_tr_b16 v[44:45], v18 offset:24576
    ds_read_b64_tr_b16 v[46:47], v18 offset:25088
    s_nop 2
    buffer_store_dwordx4 v[80:83], v21, s[16:19], s55 offen sc1
    s_add_u32 s55, s55, 65536
    buffer_store_dwordx4 v[84:87], v21, s[16:19], s55 offen sc1
    s_waitcnt lgkmcnt(8)
    v_mfma_f32_32x32x16_bf16 v[112:127], v[76:79], v[220:223], v[112:127]
    ds_read_b64_tr_b16 v[76:77], v17 offset:26624
    ds_read_b64_tr_b16 v[78:79], v17 offset:27136
    s_add_u32 s55, s55, 65536
    buffer_store_dwordx4 v[104:107], v21, s[16:19], s55 offen sc1
    s_add_u32 s55, s55, 65536
    buffer_store_dwordx4 v[108:111], v21, s[16:19], s55 offen sc1
    s_add_u32 m0, s50, 32768
    s_mul_i32 s56, s44, 196608
    s_add_u32 s56, s56, s62
    s_add_u32 s56, s56, 32768
    buffer_load_dwordx4 v7, s[20:23], s56 offen lds
    buffer_load_dwordx4 v0, s[20:23], s56 offen offset:1024 lds
    s_waitcnt lgkmcnt(8)
    v_mfma_f32_32x32x16_bf16 v[112:127], v[64:67], v[224:227], v[112:127]
    ds_read_b64_tr_b16 v[64:65], v16 offset:32768
    ds_read_b64_tr_b16 v[66:67], v16 offset:33280
    s_waitcnt lgkmcnt(8)
    v_mfma_f32_32x32x16_bf16 v[112:127], v[68:71], v[228:231], v[112:127]
    ds_read_b64_tr_b16 v[68:69], v16 offset:34816
    ds_read_b64_tr_b16 v[70:71], v16 offset:35328
    s_waitcnt lgkmcnt(8)
    v_mfma_f32_32x32x16_bf16 v[112:127], v[72:75], v[232:235], v[112:127]
    ds_read_b64_tr_b16 v[72:73], v17 offset:32768
    ds_read_b64_tr_b16 v[74:75], v17 offset:33280
    s_waitcnt lgkmcnt(8)
    v_mfma_f32_16x16x32_bf16 v[40:43], v[36:39], v[44:47], v[40:43]
    ds_read_b64_tr_b16 v[44:45], v18 offset:32768
    ds_read_b64_tr_b16 v[46:47], v18 offset:33280
    s_waitcnt lgkmcnt(8)
    v_mfma_f32_32x32x16_bf16 v[112:127], v[76:79], v[236:239], v[112:127]
    ds_read_b64_tr_b16 v[76:77], v17 offset:34816
    ds_read_b64_tr_b16 v[78:79], v17 offset:35328
    s_waitcnt lgkmcnt(8)
    v_mfma_f32_32x32x16_bf16 v[112:127], v[64:67], v[240:243], v[112:127]
    s_waitcnt lgkmcnt(6)
    v_mfma_f32_32x32x16_bf16 v[112:127], v[68:71], v[244:247], v[112:127]
    s_waitcnt lgkmcnt(4)
    v_mfma_f32_32x32x16_bf16 v[112:127], v[72:75], v[248:251], v[112:127]
    s_waitcnt lgkmcnt(2)
    v_mfma_f32_16x16x32_bf16 v[40:43], v[36:39], v[44:47], v[40:43]
    s_waitcnt lgkmcnt(0)
    v_mfma_f32_32x32x16_bf16 v[112:127], v[76:79], v[252:255], v[112:127]
    s_mov_b32 exec_hi, 0
    s_nop 4
    ds_write_b32 v30, v40 offset:2048
    s_mov_b32 exec_hi, -1
    s_waitcnt lgkmcnt(0)
    s_waitcnt vmcnt(15)
    s_waitcnt vmcnt(14)
    s_waitcnt vmcnt(11)
    s_waitcnt vmcnt(10)
    s_waitcnt vmcnt(2)
    s_barrier
    s_cmp_lg_u32 s44, 0
    s_cbranch_scc1 L_nfkv
    s_lshl_b32 s56, s48, 8
    s_add_u32 s56, s56, s47
    s_lshl_b32 s56, s56, 3
    s_add_u32 s56, s56, 14811136
    v_mov_b32 v12, s94
    v_mov_b32 v13, s95
    v_lshlrev_b32 v14, 7, v1
    s_mov_b64 exec, 0xffff
    buffer_store_dwordx2 v[12:13], v14, s[16:19], s56 offen sc1
    s_mov_b64 exec, -1
L_nfkv:
    s_nop 3
    v_and_b32 v9, 16, v1
    v_lshlrev_b32 v9, 1, v9
    v_and_b32 v10, 3, v1
    v_lshl_add_u32 v9, v10, 3, v9
    v_and_b32 v10, 8, v1
    v_lshl_add_u32 v9, v10, 3, v9
    v_bfe_u32 v10, v1, 2, 2
    v_lshl_add_u32 v9, v10, 7, v9
    v_lshrrev_b32 v10, 5, v1
    v_lshl_add_u32 v9, v10, 9, v9
    v_add_u32 v9, s50, v9
    v_xor_b32 v10, 64, v9
    v_add_u32 v2, 0x10000, v2
    ds_read_b64_tr_b16 v[64:65], v2 offset:49152
    ds_read_b64_tr_b16 v[66:67], v2 offset:49408
    ds_read_b64_tr_b16 v[68:69], v2 offset:50176
    ds_read_b64_tr_b16 v[70:71], v2 offset:50432
    ds_read_b64_tr_b16 v[72:73], v2 offset:53248
    ds_read_b64_tr_b16 v[74:75], v2 offset:53504
    ds_read_b64_tr_b16 v[76:77], v2 offset:54272
    ds_read_b64_tr_b16 v[78:79], v2 offset:54528
    v_add_u32 v3, 0x10000, v3
    ds_read_b64_tr_b16 v[44:45], v3 offset:49152
    ds_read_b64_tr_b16 v[46:47], v3 offset:49408
    ds_read_b128 v[48:51], v31 offset:2048
    s_waitcnt lgkmcnt(0)
    s_add_u32 m0, s50, 49152
    s_mul_i32 s56, s44, 196608
    s_add_u32 s56, s56, s62
    s_add_u32 s56, s56, 49152
    buffer_load_dwordx4 v7, s[20:23], s56 offen lds
    buffer_load_dwordx4 v0, s[20:23], s56 offen offset:1024 lds
    v_mfma_f32_32x32x16_bf16 v[80:95], v[64:67], v[128:131], 0
    ds_read_b64_tr_b16 v[64:65], v2 offset:57344
    ds_read_b64_tr_b16 v[66:67], v2 offset:57600
    v_add_f32 v48, v48, v49
    v_add_f32 v50, v50, v51
    v_add_f32 v48, v48, v50
    v_cvt_pk_bf16_f32 v52, v48, v48
    v_lshlrev_b32 v49, 16, v52
    v_sub_f32 v48, v48, v49
    v_cvt_pk_bf16_f32 v53, v48, 0
    v_mov_b32 v54, 0
    s_add_u32 m0, s50, 65536
    s_mul_i32 s56, s44, 196608
    s_add_u32 s56, s56, s62
    s_add_u32 s56, s56, 65536
    buffer_load_dwordx4 v7, s[20:23], s56 offen lds
    buffer_load_dwordx4 v0, s[20:23], s56 offen offset:1024 lds
    v_mfma_f32_32x32x16_bf16 v[80:95], v[68:71], v[132:135], v[80:95]
    ds_read_b64_tr_b16 v[68:69], v2 offset:58368
    ds_read_b64_tr_b16 v[70:71], v2 offset:58624
    v_mov_b32 v55, 0
    s_nop 1
    v_mfma_f32_32x32x16_bf16 v[112:127], v[52:55], v[32:35], v[112:127]
    v_mfma_f32_32x32x16_bf16 v[80:95], v[72:75], v[144:147], v[80:95]
    ds_read_b64_tr_b16 v[72:73], v2 offset:61440
    ds_read_b64_tr_b16 v[74:75], v2 offset:61696
    s_nop 7
    s_nop 0
    v_mul_f32 v112, v112, v26
    s_add_u32 m0, s50, 81920
    s_mul_i32 s56, s44, 196608
    s_add_u32 s56, s56, s62
    s_add_u32 s56, s56, 81920
    buffer_load_dwordx4 v7, s[20:23], s56 offen lds
    buffer_load_dwordx4 v0, s[20:23], s56 offen offset:1024 lds
    v_mfma_f32_16x16x32_bf16 v[40:43], v[36:39], v[44:47], 0
    ds_read_b64_tr_b16 v[44:45], v3 offset:57344
    ds_read_b64_tr_b16 v[46:47], v3 offset:57600
    v_exp_f32 v56, v112 clamp
    v_mul_f32 v113, v113, v26
    v_max_f32 v112, 0, v112
    v_exp_f32 v57, v113 clamp
    v_mul_f32 v114, v114, v26
    v_mfma_f32_32x32x16_bf16 v[80:95], v[76:79], v[148:151], v[80:95]
    ds_read_b64_tr_b16 v[76:77], v2 offset:62464
    ds_read_b64_tr_b16 v[78:79], v2 offset:62720
    v_fmaak_f32 v112, v112, v19, 0x358637bd
    v_max_f32 v113, 0, v113
    v_exp_f32 v58, v114 clamp
    v_mul_f32 v115, v115, v26
    v_add_f32 v112, v112, v56
    v_fmaak_f32 v113, v113, v19, 0x358637bd
    v_max_f32 v114, 0, v114
    s_waitcnt lgkmcnt(8)
    v_mfma_f32_32x32x16_bf16 v[80:95], v[64:67], v[160:163], v[80:95]
    v_add_u32 v2, 0x10000, v2
    ds_read_b64_tr_b16 v[64:65], v2 offset:0
    ds_read_b64_tr_b16 v[66:67], v2 offset:256
    v_exp_f32 v59, v115 clamp
    v_mul_f32 v116, v116, v26
    v_add_f32 v113, v113, v57
    v_fmaak_f32 v114, v114, v19, 0x358637bd
    v_max_f32 v115, 0, v115
    v_exp_f32 v60, v116 clamp
    s_waitcnt lgkmcnt(8)
    v_mfma_f32_32x32x16_bf16 v[80:95], v[68:71], v[164:167], v[80:95]
    ds_read_b64_tr_b16 v[68:69], v2 offset:1024
    ds_read_b64_tr_b16 v[70:71], v2 offset:1280
    v_mul_f32 v117, v117, v26
    v_cvt_pk_bf16_f32 v48, v112, v113
    v_add_f32 v114, v114, v58
    v_fmaak_f32 v115, v115, v19, 0x358637bd
    v_max_f32 v116, 0, v116
    v_exp_f32 v61, v117 clamp
    ds_read_b64_tr_b16 v[128:129], v9 offset:0
    ds_read_b64_tr_b16 v[130:131], v9 offset:1024
    ds_read_b64_tr_b16 v[132:133], v10 offset:0
    ds_read_b64_tr_b16 v[134:135], v10 offset:1024
    s_waitcnt lgkmcnt(12)
    v_mfma_f32_32x32x16_bf16 v[80:95], v[72:75], v[176:179], v[80:95]
    ds_read_b64_tr_b16 v[72:73], v2 offset:4096
    ds_read_b64_tr_b16 v[74:75], v2 offset:4352
    v_mul_f32 v118, v118, v26
    v_add_f32 v115, v115, v59
    v_fmaak_f32 v116, v116, v19, 0x358637bd
    v_max_f32 v117, 0, v117
    v_exp_f32 v62, v118 clamp
    v_mul_f32 v119, v119, v26
    s_waitcnt lgkmcnt(12)
    v_mfma_f32_16x16x32_bf16 v[40:43], v[36:39], v[44:47], v[40:43]
    v_add_u32 v3, 0x10000, v3
    ds_read_b64_tr_b16 v[44:45], v3 offset:0
    ds_read_b64_tr_b16 v[46:47], v3 offset:256
    v_cvt_pk_bf16_f32 v49, v114, v115
    v_add_f32 v116, v116, v60
    v_fmaak_f32 v117, v117, v19, 0x358637bd
    v_max_f32 v118, 0, v118
    v_exp_f32 v63, v119 clamp
    v_mul_f32 v120, v120, v26
    v_add_f32 v117, v117, v61
    ds_read_b64_tr_b16 v[136:137], v9 offset:16384
    ds_read_b64_tr_b16 v[138:139], v9 offset:17408
    ds_read_b64_tr_b16 v[140:141], v10 offset:16384
    ds_read_b64_tr_b16 v[142:143], v10 offset:17408
    s_waitcnt lgkmcnt(15)
    v_mfma_f32_32x32x16_bf16 v[80:95], v[76:79], v[180:183], v[80:95]
    ds_read_b64_tr_b16 v[76:77], v2 offset:5120
    ds_read_b64_tr_b16 v[78:79], v2 offset:5376
    v_fmaak_f32 v118, v118, v19, 0x358637bd
    v_max_f32 v119, 0, v119
    v_exp_f32 v56, v120 clamp
    v_mul_f32 v121, v121, v26
    v_cvt_pk_bf16_f32 v50, v116, v117
    v_add_f32 v118, v118, v62
    v_fmaak_f32 v119, v119, v19, 0x358637bd
    s_waitcnt lgkmcnt(10)
    s_add_u32 m0, s50, 0
    s_mul_i32 s56, s44, 196608
    s_add_u32 s56, s56, s62
    s_add_u32 s56, s56, 147456
    buffer_load_dwordx4 v7, s[20:23], s56 offen lds
    buffer_load_dwordx4 v0, s[20:23], s56 offen offset:1024 lds
    v_mfma_f32_32x32x16_bf16 v[80:95], v[64:67], v[192:195], v[80:95]
    ds_read_b64_tr_b16 v[64:65], v2 offset:8192
    ds_read_b64_tr_b16 v[66:67], v2 offset:8448
    v_max_f32 v120, 0, v120
    v_exp_f32 v57, v121 clamp
    v_mul_f32 v122, v122, v26
    v_add_f32 v119, v119, v63
    v_fmaak_f32 v120, v120, v19, 0x358637bd
    v_max_f32 v121, 0, v121
    v_mfma_f32_32x32x16_bf16 v[80:95], v[68:71], v[196:199], v[80:95]
    ds_read_b64_tr_b16 v[68:69], v2 offset:9216
    ds_read_b64_tr_b16 v[70:71], v2 offset:9472
    v_exp_f32 v58, v122 clamp
    v_mul_f32 v123, v123, v26
    v_cvt_pk_bf16_f32 v51, v118, v119
    s_add_u32 s58, s54, 114688
    buffer_store_dwordx4 v[48:51], v6, s[16:19], s58 offen sc1
    v_add_f32 v120, v120, v56
    v_fmaak_f32 v121, v121, v19, 0x358637bd
    v_max_f32 v122, 0, v122
    s_waitcnt vmcnt(9)
    ds_read_b64_tr_b16 v[144:145], v9 offset:32768
    ds_read_b64_tr_b16 v[146:147], v9 offset:33792
    ds_read_b64_tr_b16 v[148:149], v10 offset:32768
    ds_read_b64_tr_b16 v[150:151], v10 offset:33792
    s_waitcnt lgkmcnt(15)
    v_mfma_f32_32x32x16_bf16 v[80:95], v[72:75], v[208:211], v[80:95]
    ds_read_b64_tr_b16 v[72:73], v2 offset:12288
    ds_read_b64_tr_b16 v[74:75], v2 offset:12544
    v_exp_f32 v59, v123 clamp
    v_mul_f32 v124, v124, v26
    v_add_f32 v121, v121, v57
    v_fmaak_f32 v122, v122, v19, 0x358637bd
    v_max_f32 v123, 0, v123
    v_exp_f32 v60, v124 clamp
    s_waitcnt lgkmcnt(15)
    v_mfma_f32_16x16x32_bf16 v[40:43], v[36:39], v[44:47], v[40:43]
    ds_read_b64_tr_b16 v[44:45], v3 offset:8192
    ds_read_b64_tr_b16 v[46:47], v3 offset:8448
    v_mul_f32 v125, v125, v26
    v_cvt_pk_bf16_f32 v52, v120, v121
    v_add_f32 v122, v122, v58
    v_fmaak_f32 v123, v123, v19, 0x358637bd
    v_max_f32 v124, 0, v124
    v_exp_f32 v61, v125 clamp
    s_waitcnt lgkmcnt(14)
    s_add_u32 m0, s50, 16384
    s_mul_i32 s56, s44, 196608
    s_add_u32 s56, s56, s62
    s_add_u32 s56, s56, 163840
    buffer_load_dwordx4 v7, s[20:23], s56 offen lds
    buffer_load_dwordx4 v0, s[20:23], s56 offen offset:1024 lds
    s_waitcnt lgkmcnt(12)
    v_mfma_f32_32x32x16_bf16 v[80:95], v[76:79], v[212:215], v[80:95]
    ds_read_b64_tr_b16 v[76:77], v2 offset:13312
    ds_read_b64_tr_b16 v[78:79], v2 offset:13568
    v_mul_f32 v126, v126, v26
    v_add_f32 v123, v123, v59
    v_fmaak_f32 v124, v124, v19, 0x358637bd
    v_max_f32 v125, 0, v125
    v_exp_f32 v62, v126 clamp
    v_mul_f32 v127, v127, v26
    s_waitcnt lgkmcnt(12)
    v_mfma_f32_32x32x16_bf16 v[80:95], v[64:67], v[224:227], v[80:95]
    v_cvt_pk_bf16_f32 v53, v122, v123
    v_add_f32 v124, v124, v60
    v_fmaak_f32 v125, v125, v19, 0x358637bd
    v_max_f32 v126, 0, v126
    v_exp_f32 v63, v127 clamp
    v_add_f32 v125, v125, v61
    v_fmaak_f32 v126, v126, v19, 0x358637bd
    s_waitcnt lgkmcnt(6)
    s_add_u32 m0, s50, 32768
    s_mul_i32 s56, s44, 196608
    s_add_u32 s56, s56, s62
    s_add_u32 s56, s56, 180224
    buffer_load_dwordx4 v7, s[20:23], s56 offen lds
    buffer_load_dwordx4 v0, s[20:23], s56 offen offset:1024 lds
    v_mfma_f32_32x32x16_bf16 v[80:95], v[68:71], v[228:231], v[80:95]
    v_max_f32 v127, 0, v127
    v_cvt_pk_bf16_f32 v54, v124, v125
    v_add_f32 v126, v126, v62
    v_fmaak_f32 v127, v127, v19, 0x358637bd
    v_add_f32 v127, v127, v63
    v_cvt_pk_bf16_f32 v55, v126, v127
    s_add_u32 s58, s54, 115712
    buffer_store_dwordx4 v[52:55], v6, s[16:19], s58 offen sc1
    s_waitcnt lgkmcnt(4)
    v_mfma_f32_32x32x16_bf16 v[80:95], v[72:75], v[240:243], v[80:95]
    s_waitcnt lgkmcnt(2)
    v_mfma_f32_16x16x32_bf16 v[40:43], v[36:39], v[44:47], v[40:43]
    s_waitcnt lgkmcnt(0)
    v_mfma_f32_32x32x16_bf16 v[80:95], v[76:79], v[244:247], v[80:95]
    s_mov_b32 exec_hi, 0
    s_nop 4
    ds_write_b32 v30, v40 offset:0
    s_mov_b32 exec_hi, -1
    v_add_u32 v12, s50, v6
    v_add_u32 v13, 98304, v12
    v_xor_b32 v12, 8192, v13
    s_cmp_eq_u32 s46, 1
    s_cbranch_scc1 L_x1
    s_nop 7
    s_nop 4
    ds_write_b128 v12, v[88:91]
    ds_write_b128 v12, v[92:95] offset:1024
    s_branch L_x2
L_x1:
    s_nop 7
    s_nop 4
    ds_write_b128 v12, v[80:83]
    ds_write_b128 v12, v[84:87] offset:1024
L_x2:
    s_waitcnt lgkmcnt(0)
    s_barrier
    ds_read_b128 v[96:99], v13
    ds_read_b128 v[100:103], v13 offset:1024
    ds_read_b128 v[48:51], v31 offset:0
    v_xor_b32 v56, 512, v31
    ds_read_b128 v[56:59], v56 offset:0
    s_waitcnt lgkmcnt(0)
    v_add_f32 v48, v48, v56
    v_add_f32 v49, v49, v57
    v_add_f32 v50, v50, v58
    v_add_f32 v51, v51, v59
    v_add_f32 v48, v48, v49
    v_add_f32 v50, v50, v51
    v_add_f32 v48, v48, v50
    v_cvt_pk_bf16_f32 v52, v48, v48
    v_lshlrev_b32 v49, 16, v52
    v_sub_f32 v48, v48, v49
    v_lshlrev_b32 v49, 16, v27
    v_cvt_pk_bf16_f32 v53, v48, v49
    v_mov_b32 v54, v27
    v_mov_b32 v55, 0
    s_nop 1
    v_mfma_f32_32x32x16_bf16 v[80:95], v[52:55], v[32:35], v[80:95]
    s_nop 7
    s_nop 4
    s_cmp_eq_u32 s46, 0
    s_cbranch_scc1 L_x3
    v_mov_b32 v80, v88
    v_mov_b32 v81, v89
    v_mov_b32 v82, v90
    v_mov_b32 v83, v91
    v_mov_b32 v84, v92
    v_mov_b32 v85, v93
    v_mov_b32 v86, v94
    v_mov_b32 v87, v95
L_x3:
    v_pk_add_f32 v[80:81], v[80:81], v[96:97]
    v_pk_add_f32 v[82:83], v[82:83], v[98:99]
    v_pk_add_f32 v[84:85], v[84:85], v[100:101]
    v_pk_add_f32 v[86:87], v[86:87], v[102:103]
    s_lshl_b32 s56, s48, 11
    s_sub_u32 s54, s54, s56
    s_lshl_b32 s56, s46, 10
    s_sub_u32 s54, s54, s56
    v_mul_f32 v56, v80, v80
    v_fma_f32 v56, v56, v23, v22
    v_mul_f32 v57, v81, v81
    v_mul_f32 v56, v56, v80
    v_fma_f32 v57, v57, v23, v22
    v_mul_f32 v58, v82, v82
    v_exp_f32 v56, v56
    v_mul_f32 v57, v57, v81
    v_fma_f32 v58, v58, v23, v22
    v_mul_f32 v59, v83, v83
    v_fma_f32 v56, v56, v24, v24
    v_exp_f32 v57, v57
    v_mul_f32 v58, v58, v82
    v_fma_f32 v59, v59, v23, v22
    v_mul_f32 v60, v84, v84
    v_rcp_f32 v56, v56
    v_fma_f32 v57, v57, v24, v24
    v_exp_f32 v58, v58
    v_mul_f32 v59, v59, v83
    v_fma_f32 v60, v60, v23, v22
    v_mul_f32 v61, v85, v85
    v_mul_f32 v80, v56, v80
    v_rcp_f32 v57, v57
    v_fma_f32 v58, v58, v24, v24
    v_exp_f32 v59, v59
    v_mul_f32 v60, v60, v84
    v_fma_f32 v61, v61, v23, v22
    v_mul_f32 v62, v86, v86
    v_mul_f32 v81, v57, v81
    v_rcp_f32 v58, v58
    v_fma_f32 v59, v59, v24, v24
    v_exp_f32 v60, v60
    v_mul_f32 v61, v61, v85
    v_fma_f32 v62, v62, v23, v22
    v_mul_f32 v63, v87, v87
    v_cvt_pk_bf16_f32 v48, v80, v81
    v_mul_f32 v82, v58, v82
    v_rcp_f32 v59, v59
    v_fma_f32 v60, v60, v24, v24
    v_exp_f32 v61, v61
    v_mul_f32 v62, v62, v86
    v_fma_f32 v63, v63, v23, v22
    v_mul_f32 v83, v59, v83
    v_rcp_f32 v60, v60
    v_fma_f32 v61, v61, v24, v24
    v_exp_f32 v62, v62
    v_mul_f32 v63, v63, v87
    v_cvt_pk_bf16_f32 v49, v82, v83
    v_mul_f32 v84, v60, v84
    v_rcp_f32 v61, v61
    v_fma_f32 v62, v62, v24, v24
    v_exp_f32 v63, v63
    v_mul_f32 v85, v61, v85
    v_rcp_f32 v62, v62
    v_fma_f32 v63, v63, v24, v24
    v_cvt_pk_bf16_f32 v50, v84, v85
    v_mul_f32 v86, v62, v86
    v_rcp_f32 v63, v63
    s_nop 0
    v_mul_f32 v87, v63, v87
    v_cvt_pk_bf16_f32 v51, v86, v87
    s_add_u32 s58, s54, 98304
    buffer_store_dwordx4 v[48:51], v6, s[16:19], s58 offen sc1
    s_add_u32 m0, s50, 114688
    s_mul_i32 s56, s44, 196608
    s_add_u32 s56, s56, s62
    s_add_u32 s56, s56, 114688
    buffer_load_dwordx4 v7, s[20:23], s56 offen lds
    buffer_load_dwordx4 v0, s[20:23], s56 offen offset:1024 lds
    s_add_u32 m0, s50, 131072
    s_mul_i32 s56, s44, 196608
    s_add_u32 s56, s56, s62
    s_add_u32 s56, s56, 131072
    buffer_load_dwordx4 v7, s[20:23], s56 offen lds
    buffer_load_dwordx4 v0, s[20:23], s56 offen offset:1024 lds
    s_add_u32 m0, s50, 98304
    s_mul_i32 s56, s44, 196608
    s_add_u32 s56, s56, s62
    s_add_u32 s56, s56, 98304
    buffer_load_dwordx4 v7, s[20:23], s56 offen lds
    buffer_load_dwordx4 v0, s[20:23], s56 offen offset:1024 lds
    s_waitcnt vmcnt(6)
    v_mov_b32 v20, 163328
    v_mov_b32 v21, 1
    s_mov_b64 exec, 1
    ds_add_rtn_u32 v21, v20, v21
    s_mov_b64 exec, -1
    s_waitcnt lgkmcnt(0)
    v_readfirstlane_b32 s56, v21
    s_nop 0
    s_cmp_lg_u32 s56, 7
    s_cbranch_scc1 L_nfh2A
    s_add_u32 s56, s51, 32768
    v_mov_b32 v20, s94
    v_mov_b32 v21, s95
    v_lshlrev_b32 v22, 0, v1
    s_mov_b64 exec, 0x1
    buffer_store_dwordx2 v[20:21], v22, s[16:19], s56 offen sc1
    s_mov_b64 exec, -1
L_nfh2A:
    s_nop 3
    ds_read_b64_tr_b16 v[152:153], v9 offset:49152
    ds_read_b64_tr_b16 v[154:155], v9 offset:50176
    ds_read_b64_tr_b16 v[156:157], v10 offset:49152
    ds_read_b64_tr_b16 v[158:159], v10 offset:50176
    v_add_u32 v9, 0x10000, v9
    ds_read_b64_tr_b16 v[160:161], v9 offset:0
    ds_read_b64_tr_b16 v[162:163], v9 offset:1024
    v_add_u32 v10, 0x10000, v10
    ds_read_b64_tr_b16 v[164:165], v10 offset:0
    ds_read_b64_tr_b16 v[166:167], v10 offset:1024
    s_waitcnt lgkmcnt(4)
    s_add_u32 m0, s50, 49152
    s_mul_i32 s56, s44, 32768
    s_add_u32 s56, s56, s62
    s_add_u32 s56, s56, 1572864
    buffer_load_dwordx4 v7, s[20:23], s56 offen lds
    buffer_load_dwordx4 v0, s[20:23], s56 offen offset:1024 lds
    s_waitcnt lgkmcnt(0)
    s_add_u32 m0, s50, 65536
    s_mul_i32 s56, s44, 32768
    s_add_u32 s56, s56, s62
    s_add_u32 s56, s56, 1589248
    buffer_load_dwordx4 v7, s[20:23], s56 offen lds
    buffer_load_dwordx4 v0, s[20:23], s56 offen offset:1024 lds
    v_mov_b32 v4, 0
    s_lshr_b32 s53, s59, 1
    s_lshl_b32 s53, s53, 4
    s_add_u32 s53, s53, s44
    s_lshl_b32 s53, s53, 7
    s_add_u32 s64, s53, 14746624
    s_add_u32 s53, s53, 14778368
    s_add_u32 s52, s53, 1024
    buffer_load_dwordx2 v[2:3], v4, s[16:19], s64 offen sc1
    s_setprio 3
    s_branch L_p2
L_roleH:
    v_lshrrev_b32 v48, 3, v1
    v_mul_u32_u24 v4, 3584, v48
    v_lshrrev_b32 v48, 2, v1
    v_and_b32 v48, 4, v48
    v_and_b32 v49, 7, v1
    v_xor_b32 v48, v48, v49
    v_lshl_add_u32 v4, v48, 4, v4
    s_mul_i32 s52, s44, 28672
    s_sub_u32 s48, s48, 8
    s_mul_i32 s56, s48, 384
    s_add_u32 s52, s52, s56
    s_add_u32 s56, s63, 0
    s_and_b32 s56, s56, 7
    s_lshl_b32 s57, s56, 7
    s_add_u32 s64, s51, s57
    s_mul_i32 s57, s56, 229376
    s_add_u32 s72, s52, s57
    s_add_u32 s56, s63, 1
    s_and_b32 s56, s56, 7
    s_lshl_b32 s57, s56, 7
    s_add_u32 s65, s51, s57
    s_mul_i32 s57, s56, 229376
    s_add_u32 s73, s52, s57
    s_add_u32 m0, s50, 114688
    s_nop 0
    buffer_load_dwordx4 v12, s[4:7], s64 offen lds
    buffer_load_dwordx4 v13, s[4:7], s64 offen offset:1024 lds
    s_add_u32 m0, s49, 131072
    s_add_u32 s56, s72, 0
    buffer_load_dwordx4 v4, s[12:15], s56 offen lds
    s_add_u32 s56, s63, 2
    s_and_b32 s56, s56, 7
    s_lshl_b32 s57, s56, 7
    s_add_u32 s66, s51, s57
    s_mul_i32 s57, s56, 229376
    s_add_u32 s74, s52, s57
    s_add_u32 s56, s63, 3
    s_and_b32 s56, s56, 7
    s_lshl_b32 s57, s56, 7
    s_add_u32 s67, s51, s57
    s_mul_i32 s57, s56, 229376
    s_add_u32 s75, s52, s57
    s_add_u32 s56, s63, 4
    s_and_b32 s56, s56, 7
    s_lshl_b32 s57, s56, 7
    s_add_u32 s68, s51, s57
    s_mul_i32 s57, s56, 229376
    s_add_u32 s76, s52, s57
    s_add_u32 s56, s63, 5
    s_and_b32 s56, s56, 7
    s_lshl_b32 s57, s56, 7
    s_add_u32 s69, s51, s57
    s_mul_i32 s57, s56, 229376
    s_add_u32 s77, s52, s57
    s_add_u32 s56, s63, 6
    s_and_b32 s56, s56, 7
    s_lshl_b32 s57, s56, 7
    s_add_u32 s70, s51, s57
    s_mul_i32 s57, s56, 229376
    s_add_u32 s78, s52, s57
    s_add_u32 s56, s63, 7
    s_and_b32 s56, s56, 7
    s_lshl_b32 s57, s56, 7
    s_add_u32 s71, s51, s57
    s_mul_i32 s57, s56, 229376
    s_add_u32 s79, s52, s57
    v_lshrrev_b32 v48, 3, v1
    v_mul_u32_u24 v7, 1024, v48
    v_lshrrev_b32 v48, 2, v1
    v_and_b32 v48, 4, v48
    v_and_b32 v49, 7, v1
    v_xor_b32 v48, v48, v49
    v_lshl_add_u32 v7, v48, 4, v7
    v_add_u32 v0, 7168, v7
    s_lshl_b32 s62, s60, 7
    s_lshl_b32 s51, s47, 4
    s_add_u32 s51, s51, s48
    s_lshl_b32 s51, s51, 7
    s_add_u32 s51, s51, 14746624
    s_mov_b32 s3, s46
    s_or_b32 s56, s2, s44
    s_cmp_lg_u32 s56, 0
    s_cbranch_scc1 L_nn0
    s_memrealtime s[56:57]
    s_waitcnt lgkmcnt(0)
    s_or_b32 s56, s56, 1
    v_mov_b32 v48, s56
    v_mov_b32 v49, s57
    v_mov_b32 v50, 0
    buffer_store_dwordx2 v[48:49], v50, s[40:43], 0 offen sc1
L_nn0:
    s_add_u32 m0, s50, 0
    s_nop 0
    buffer_load_dwordx4 v12, s[4:7], s65 offen lds
    buffer_load_dwordx4 v13, s[4:7], s65 offen offset:1024 lds
    s_add_u32 m0, s49, 139264
    s_add_u32 s56, s73, 0
    buffer_load_dwordx4 v4, s[12:15], s56 offen lds
    v_and_b32 v48, 31, v1
    v_lshlrev_b32 v48, 1, v48
    s_lshl_b32 s57, s46, 6
    s_add_u32 s56, s56, s57
    s_mul_i32 s56, s48, 384
    s_add_u32 s56, s56, s57
    buffer_load_ushort v27, v48, s[32:35], s56 offen offset:0
    buffer_load_ushort v28, v48, s[32:35], s56 offen offset:128
    buffer_load_ushort v29, v48, s[32:35], s56 offen offset:256
    s_lshl_b32 s54, s47, 2
    s_add_u32 s54, s54, s45
    s_mul_i32 s54, s54, 147456
    s_mul_i32 s56, s48, 12288
    s_add_u32 s54, s54, s56
    s_lshl_b32 s56, s46, 11
    s_add_u32 s54, s54, s56
    v_and_b32 v48, 31, v1
    v_lshlrev_b32 v49, 7, v48
    v_bfe_u32 v48, v1, 1, 3
    v_lshrrev_b32 v50, 5, v1
    v_xor_b32 v48, v48, v50
    v_lshl_add_u32 v49, v48, 4, v49
    s_lshl_b32 s56, s45, 12
    v_add_u32 v49, s56, v49
    s_lshl_b32 s56, s46, 6
    v_xor_b32 v8, s56, v49
    v_xor_b32 v9, 32, v8
    v_xor_b32 v10, 64, v8
    v_xor_b32 v11, 96, v8
    v_and_b32 v49, 16, v1
    v_lshlrev_b32 v49, 1, v49
    v_and_b32 v48, 3, v1
    v_lshl_add_u32 v49, v48, 3, v49
    v_and_b32 v48, 8, v1
    v_lshl_add_u32 v49, v48, 3, v49
    v_bfe_u32 v48, v1, 2, 2
    v_lshl_add_u32 v49, v48, 7, v49
    v_xor_b32 v49, s56, v49
    v_lshrrev_b32 v50, 5, v1
    v_lshl_add_u32 v48, v50, 10, v49
    s_lshl_b32 s57, s46, 12
    v_add_u32 v16, s57, v48
    v_xor_b32 v17, 4096, v16
    s_lshl_b32 s57, s45, 11
    v_add_u32 v18, s57, v48
    v_and_b32 v48, 31, v1
    v_cmp_eq_u32 vcc, 0, v48
    v_cmp_eq_u32 s[56:57], 20, v48
    s_nop 0
    s_or_b64 vcc, vcc, s[56:57]
    v_mov_b32 v49, 0x3f803f80
    v_cndmask_b32 v36, 0, v49, vcc
    v_mov_b32 v37, v36
    v_mov_b32 v38, v36
    v_mov_b32 v39, v36
    v_lshlrev_b32 v31, 4, v48
    s_lshl_b32 s56, s46, 9
    s_add_u32 s56, s56, 159744
    v_add_u32 v31, s56, v31
    s_lshl_b32 s56, s45, 2
    v_add_u32 v30, s56, v31
    v_mov_b32 v14, 0
    v_mov_b32 v15, 0
    v_mov_b32 v48, 163328
    ds_write_b64 v48, v[14:15]
    s_waitcnt lgkmcnt(0)
    s_waitcnt vmcnt(7)
    s_waitcnt vmcnt(6)
    s_barrier
    v_add_u32 v8, 0x10000, v8
    ds_read_b128 v[128:131], v8 offset:49152
    v_add_u32 v9, 0x10000, v9
    ds_read_b128 v[132:135], v9 offset:49152
    v_add_u32 v10, 0x10000, v10
    ds_read_b128 v[136:139], v10 offset:49152
    v_add_u32 v11, 0x10000, v11
    ds_read_b128 v[140:143], v11 offset:49152
    v_add_u32 v16, 0x20000, v16
    ds_read_b64_tr_b16 v[64:65], v16 offset:0
    ds_read_b64_tr_b16 v[66:67], v16 offset:512
    ds_read_b64_tr_b16 v[68:69], v16 offset:2048
    ds_read_b64_tr_b16 v[70:71], v16 offset:2560
    v_add_u32 v17, 0x20000, v17
    ds_read_b64_tr_b16 v[72:73], v17 offset:0
    ds_read_b64_tr_b16 v[74:75], v17 offset:512
    ds_read_b64_tr_b16 v[76:77], v17 offset:2048
    ds_read_b64_tr_b16 v[78:79], v17 offset:2560
    v_add_u32 v18, 0x20000, v18
    ds_read_b64_tr_b16 v[56:57], v18 offset:0
    ds_read_b64_tr_b16 v[58:59], v18 offset:512
    s_add_u32 m0, s50, 16384
    s_nop 0
    buffer_load_dwordx4 v12, s[4:7], s66 offen lds
    buffer_load_dwordx4 v13, s[4:7], s66 offen offset:1024 lds
    s_add_u32 m0, s49, 49152
    s_add_u32 s56, s74, 0
    buffer_load_dwordx4 v4, s[12:15], s56 offen lds
    s_waitcnt vmcnt(7)
    s_waitcnt vmcnt(6)
    s_barrier
    v_add_u32 v8, 0xffff0000, v8
    ds_read_b128 v[144:147], v8 offset:0
    v_add_u32 v9, 0xffff0000, v9
    ds_read_b128 v[148:151], v9 offset:0
    v_add_u32 v10, 0xffff0000, v10
    ds_read_b128 v[152:155], v10 offset:0
    v_add_u32 v11, 0xffff0000, v11
    ds_read_b128 v[156:159], v11 offset:0
    s_waitcnt lgkmcnt(15)
    s_waitcnt lgkmcnt(12)
    v_mfma_f32_32x32x16_bf16 v[80:95], v[64:67], v[128:131], 0
    ds_read_b64_tr_b16 v[64:65], v16 offset:8192
    ds_read_b64_tr_b16 v[66:67], v16 offset:8704
    s_add_u32 m0, s50, 32768
    s_nop 0
    buffer_load_dwordx4 v12, s[4:7], s67 offen lds
    buffer_load_dwordx4 v13, s[4:7], s67 offen offset:1024 lds
    v_lshlrev_b32 v48, 16, v128
    v_and_b32 v49, 0xffff0000, v128
    v_add_f32 v14, v14, v48
    v_fmac_f32 v15, v48, v48
    v_add_f32 v14, v14, v49
    v_fmac_f32 v15, v49, v49
    v_lshlrev_b32 v50, 16, v129
    v_and_b32 v51, 0xffff0000, v129
    v_add_f32 v14, v14, v50
    s_waitcnt lgkmcnt(12)
    v_mfma_f32_32x32x16_bf16 v[80:95], v[68:71], v[132:135], v[80:95]
    ds_read_b64_tr_b16 v[68:69], v16 offset:10240
    ds_read_b64_tr_b16 v[70:71], v16 offset:10752
    s_add_u32 m0, s49, 57344
    s_add_u32 s56, s75, 0
    buffer_load_dwordx4 v4, s[12:15], s56 offen lds
    v_fmac_f32 v15, v50, v50
    v_add_f32 v14, v14, v51
    v_fmac_f32 v15, v51, v51
    v_lshlrev_b32 v52, 16, v130
    v_and_b32 v53, 0xffff0000, v130
    v_add_f32 v14, v14, v52
    v_fmac_f32 v15, v52, v52
    v_add_f32 v14, v14, v53
    v_fmac_f32 v15, v53, v53
    v_lshlrev_b32 v54, 16, v131
    s_waitcnt lgkmcnt(8)
    v_mfma_f32_16x16x32_bf16 v[40:43], v[36:39], v[56:59], 0
    ds_read_b64_tr_b16 v[56:57], v18 offset:8192
    ds_read_b64_tr_b16 v[58:59], v18 offset:8704
    v_and_b32 v55, 0xffff0000, v131
    v_add_f32 v14, v14, v54
    v_fmac_f32 v15, v54, v54
    v_add_f32 v14, v14, v55
    v_fmac_f32 v15, v55, v55
    v_lshlrev_b32 v48, 16, v132
    v_and_b32 v49, 0xffff0000, v132
    v_add_f32 v14, v14, v48
    v_fmac_f32 v15, v48, v48
    v_add_f32 v14, v14, v49
    v_mfma_f32_32x32x16_bf16 v[80:95], v[72:75], v[136:139], v[80:95]
    ds_read_b64_tr_b16 v[72:73], v17 offset:8192
    ds_read_b64_tr_b16 v[74:75], v17 offset:8704
    s_add_u32 m0, s50, 65536
    s_nop 0
    buffer_load_dwordx4 v12, s[4:7], s68 offen lds
    buffer_load_dwordx4 v13, s[4:7], s68 offen offset:1024 lds
    v_fmac_f32 v15, v49, v49
    v_lshlrev_b32 v50, 16, v133
    v_and_b32 v51, 0xffff0000, v133
    v_add_f32 v14, v14, v50
    v_fmac_f32 v15, v50, v50
    v_add_f32 v14, v14, v51
    v_fmac_f32 v15, v51, v51
    v_lshlrev_b32 v52, 16, v134
    v_and_b32 v53, 0xffff0000, v134
    v_add_f32 v14, v14, v52
    v_mfma_f32_32x32x16_bf16 v[80:95], v[76:79], v[140:143], v[80:95]
    ds_read_b64_tr_b16 v[76:77], v17 offset:10240
    ds_read_b64_tr_b16 v[78:79], v17 offset:10752
    v_fmac_f32 v15, v52, v52
    v_add_f32 v14, v14, v53
    v_fmac_f32 v15, v53, v53
    v_lshlrev_b32 v54, 16, v135
    v_and_b32 v55, 0xffff0000, v135
    v_add_f32 v14, v14, v54
    v_fmac_f32 v15, v54, v54
    v_add_f32 v14, v14, v55
    v_fmac_f32 v15, v55, v55
    s_waitcnt vmcnt(6)
    s_waitcnt vmcnt(5)
    s_barrier
    ds_read_b128 v[160:163], v8 offset:16384
    ds_read_b128 v[164:167], v9 offset:16384
    ds_read_b128 v[168:171], v10 offset:16384
    ds_read_b128 v[172:175], v11 offset:16384
    s_waitcnt lgkmcnt(15)
    s_waitcnt lgkmcnt(12)
    v_mfma_f32_32x32x16_bf16 v[80:95], v[64:67], v[144:147], v[80:95]
    v_add_u32 v16, 0xfffe0000, v16
    ds_read_b64_tr_b16 v[64:65], v16 offset:49152
    ds_read_b64_tr_b16 v[66:67], v16 offset:49664
    s_add_u32 m0, s49, 98304
    s_add_u32 s56, s76, 0
    buffer_load_dwordx4 v4, s[12:15], s56 offen lds
    v_lshlrev_b32 v48, 16, v144
    v_and_b32 v49, 0xffff0000, v144
    v_add_f32 v14, v14, v48
    v_fmac_f32 v15, v48, v48
    v_add_f32 v14, v14, v49
    v_fmac_f32 v15, v49, v49
    v_lshlrev_b32 v50, 16, v145
    v_and_b32 v51, 0xffff0000, v145
    v_add_f32 v14, v14, v50
    s_waitcnt lgkmcnt(12)
    v_mfma_f32_32x32x16_bf16 v[80:95], v[68:71], v[148:151], v[80:95]
    ds_read_b64_tr_b16 v[68:69], v16 offset:51200
    ds_read_b64_tr_b16 v[70:71], v16 offset:51712
    s_add_u32 m0, s50, 81920
    s_nop 0
    buffer_load_dwordx4 v12, s[4:7], s69 offen lds
    buffer_load_dwordx4 v13, s[4:7], s69 offen offset:1024 lds
    v_fmac_f32 v15, v50, v50
    v_add_f32 v14, v14, v51
    v_fmac_f32 v15, v51, v51
    v_lshlrev_b32 v52, 16, v146
    v_and_b32 v53, 0xffff0000, v146
    v_add_f32 v14, v14, v52
    v_fmac_f32 v15, v52, v52
    v_add_f32 v14, v14, v53
    v_fmac_f32 v15, v53, v53
    v_lshlrev_b32 v54, 16, v147
    s_waitcnt lgkmcnt(12)
    v_mfma_f32_16x16x32_bf16 v[40:43], v[36:39], v[56:59], v[40:43]
    v_add_u32 v18, 0xfffe0000, v18
    ds_read_b64_tr_b16 v[56:57], v18 offset:49152
    ds_read_b64_tr_b16 v[58:59], v18 offset:49664
    v_and_b32 v55, 0xffff0000, v147
    v_add_f32 v14, v14, v54
    v_fmac_f32 v15, v54, v54
    v_add_f32 v14, v14, v55
    v_fmac_f32 v15, v55, v55
    v_lshlrev_b32 v48, 16, v148
    v_and_b32 v49, 0xffff0000, v148
    v_add_f32 v14, v14, v48
    v_fmac_f32 v15, v48, v48
    v_add_f32 v14, v14, v49
    s_waitcnt lgkmcnt(12)
    v_mfma_f32_32x32x16_bf16 v[80:95], v[72:75], v[152:155], v[80:95]
    v_add_u32 v17, 0xfffe0000, v17
    ds_read_b64_tr_b16 v[72:73], v17 offset:49152
    ds_read_b64_tr_b16 v[74:75], v17 offset:49664
    s_add_u32 m0, s49, 106496
    s_add_u32 s56, s77, 0
    buffer_load_dwordx4 v4, s[12:15], s56 offen lds
    v_fmac_f32 v15, v49, v49
    v_lshlrev_b32 v50, 16, v149
    v_and_b32 v51, 0xffff0000, v149
    v_add_f32 v14, v14, v50
    v_fmac_f32 v15, v50, v50
    v_add_f32 v14, v14, v51
    v_fmac_f32 v15, v51, v51
    v_lshlrev_b32 v52, 16, v150
    v_and_b32 v53, 0xffff0000, v150
    v_add_f32 v14, v14, v52
    s_waitcnt lgkmcnt(12)
    v_mfma_f32_32x32x16_bf16 v[80:95], v[76:79], v[156:159], v[80:95]
    ds_read_b64_tr_b16 v[76:77], v17 offset:51200
    ds_read_b64_tr_b16 v[78:79], v17 offset:51712
    v_fmac_f32 v15, v52, v52
    v_add_f32 v14, v14, v53
    v_fmac_f32 v15, v53, v53
    v_lshlrev_b32 v54, 16, v151
    v_and_b32 v55, 0xffff0000, v151
    v_add_f32 v14, v14, v54
    v_fmac_f32 v15, v54, v54
    v_add_f32 v14, v14, v55
    v_fmac_f32 v15, v55, v55
    s_waitcnt vmcnt(7)
    s_waitcnt vmcnt(6)
    s_barrier
    ds_read_b128 v[176:179], v8 offset:32768
    ds_read_b128 v[180:183], v9 offset:32768
    ds_read_b128 v[184:187], v10 offset:32768
    ds_read_b128 v[188:191], v11 offset:32768
    s_waitcnt lgkmcnt(15)
    s_waitcnt lgkmcnt(12)
    v_mfma_f32_32x32x16_bf16 v[80:95], v[64:67], v[160:163], v[80:95]
    ds_read_b64_tr_b16 v[64:65], v16 offset:57344
    ds_read_b64_tr_b16 v[66:67], v16 offset:57856
    s_add_u32 m0, s50, 114688
    s_nop 0
    buffer_load_dwordx4 v12, s[4:7], s70 offen lds
    buffer_load_dwordx4 v13, s[4:7], s70 offen offset:1024 lds
    v_lshlrev_b32 v48, 16, v160
    v_and_b32 v49, 0xffff0000, v160
    v_add_f32 v14, v14, v48
    v_fmac_f32 v15, v48, v48
    v_add_f32 v14, v14, v49
    v_fmac_f32 v15, v49, v49
    v_lshlrev_b32 v50, 16, v161
    v_and_b32 v51, 0xffff0000, v161
    v_add_f32 v14, v14, v50
    s_waitcnt lgkmcnt(12)
    v_mfma_f32_32x32x16_bf16 v[80:95], v[68:71], v[164:167], v[80:95]
    ds_read_b64_tr_b16 v[68:69], v16 offset:59392
    ds_read_b64_tr_b16 v[70:71], v16 offset:59904
    s_add_u32 m0, s49, 147456
    s_add_u32 s56, s78, 0
    buffer_load_dwordx4 v4, s[12:15], s56 offen lds
    v_fmac_f32 v15, v50, v50
    v_add_f32 v14, v14, v51
    v_fmac_f32 v15, v51, v51
    v_lshlrev_b32 v52, 16, v162
    v_and_b32 v53, 0xffff0000, v162
    v_add_f32 v14, v14, v52
    v_fmac_f32 v15, v52, v52
    v_add_f32 v14, v14, v53
    v_fmac_f32 v15, v53, v53
    v_lshlrev_b32 v54, 16, v163
    s_waitcnt lgkmcnt(12)
    v_mfma_f32_16x16x32_bf16 v[40:43], v[36:39], v[56:59], v[40:43]
    ds_read_b64_tr_b16 v[56:57], v18 offset:57344
    ds_read_b64_tr_b16 v[58:59], v18 offset:57856
    v_and_b32 v55, 0xffff0000, v163
    v_add_f32 v14, v14, v54
    v_fmac_f32 v15, v54, v54
    v_add_f32 v14, v14, v55
    v_fmac_f32 v15, v55, v55
    v_lshlrev_b32 v48, 16, v164
    v_and_b32 v49, 0xffff0000, v164
    v_add_f32 v14, v14, v48
    v_fmac_f32 v15, v48, v48
    v_add_f32 v14, v14, v49
    s_waitcnt lgkmcnt(12)
    v_mfma_f32_32x32x16_bf16 v[80:95], v[72:75], v[168:171], v[80:95]
    ds_read_b64_tr_b16 v[72:73], v17 offset:57344
    ds_read_b64_tr_b16 v[74:75], v17 offset:57856
    s_add_u32 m0, s50, 0
    s_nop 0
    buffer_load_dwordx4 v12, s[4:7], s71 offen lds
    buffer_load_dwordx4 v13, s[4:7], s71 offen offset:1024 lds
    v_fmac_f32 v15, v49, v49
    v_lshlrev_b32 v50, 16, v165
    v_and_b32 v51, 0xffff0000, v165
    v_add_f32 v14, v14, v50
    v_fmac_f32 v15, v50, v50
    v_add_f32 v14, v14, v51
    v_fmac_f32 v15, v51, v51
    v_lshlrev_b32 v52, 16, v166
    v_and_b32 v53, 0xffff0000, v166
    v_add_f32 v14, v14, v52
    s_waitcnt lgkmcnt(12)
    v_mfma_f32_32x32x16_bf16 v[80:95], v[76:79], v[172:175], v[80:95]
    ds_read_b64_tr_b16 v[76:77], v17 offset:59392
    ds_read_b64_tr_b16 v[78:79], v17 offset:59904
    v_fmac_f32 v15, v52, v52
    v_add_f32 v14, v14, v53
    v_fmac_f32 v15, v53, v53
    v_lshlrev_b32 v54, 16, v167
    v_and_b32 v55, 0xffff0000, v167
    v_add_f32 v14, v14, v54
    v_fmac_f32 v15, v54, v54
    v_add_f32 v14, v14, v55
    v_fmac_f32 v15, v55, v55
    s_waitcnt vmcnt(9)
    s_waitcnt vmcnt(8)
    s_barrier
    v_add_u32 v8, 0x10000, v8
    ds_read_b128 v[192:195], v8 offset:0
    v_add_u32 v9, 0x10000, v9
    ds_read_b128 v[196:199], v9 offset:0
    v_add_u32 v10, 0x10000, v10
    ds_read_b128 v[200:203], v10 offset:0
    v_add_u32 v11, 0x10000, v11
    ds_read_b128 v[204:207], v11 offset:0
    s_waitcnt lgkmcnt(15)
    s_waitcnt lgkmcnt(12)
    v_mfma_f32_32x32x16_bf16 v[80:95], v[64:67], v[176:179], v[80:95]
    v_add_u32 v16, 0x10000, v16
    ds_read_b64_tr_b16 v[64:65], v16 offset:32768
    ds_read_b64_tr_b16 v[66:67], v16 offset:33280
    s_add_u32 m0, s49, 131072
    s_add_u32 s56, s79, 0
    buffer_load_dwordx4 v4, s[12:15], s56 offen lds
    v_lshlrev_b32 v48, 16, v176
    v_and_b32 v49, 0xffff0000, v176
    v_add_f32 v14, v14, v48
    v_fmac_f32 v15, v48, v48
    v_add_f32 v14, v14, v49
    v_fmac_f32 v15, v49, v49
    v_lshlrev_b32 v50, 16, v177
    v_and_b32 v51, 0xffff0000, v177
    v_add_f32 v14, v14, v50
    s_waitcnt lgkmcnt(12)
    v_mfma_f32_32x32x16_bf16 v[80:95], v[68:71], v[180:183], v[80:95]
    ds_read_b64_tr_b16 v[68:69], v16 offset:34816
    ds_read_b64_tr_b16 v[70:71], v16 offset:35328
    s_add_u32 m0, s49, 16384
    s_add_u32 s56, s72, 128
    buffer_load_dwordx4 v4, s[12:15], s56 offen lds
    v_fmac_f32 v15, v50, v50
    v_add_f32 v14, v14, v51
    v_fmac_f32 v15, v51, v51
    v_lshlrev_b32 v52, 16, v178
    v_and_b32 v53, 0xffff0000, v178
    v_add_f32 v14, v14, v52
    v_fmac_f32 v15, v52, v52
    v_add_f32 v14, v14, v53
    v_fmac_f32 v15, v53, v53
    v_lshlrev_b32 v54, 16, v179
    s_waitcnt lgkmcnt(12)
    v_mfma_f32_16x16x32_bf16 v[40:43], v[36:39], v[56:59], v[40:43]
    v_add_u32 v18, 0x10000, v18
    ds_read_b64_tr_b16 v[56:57], v18 offset:32768
    ds_read_b64_tr_b16 v[58:59], v18 offset:33280
    s_add_u32 m0, s49, 24576
    s_add_u32 s56, s73, 128
    buffer_load_dwordx4 v4, s[12:15], s56 offen lds
    v_and_b32 v55, 0xffff0000, v179
    v_add_f32 v14, v14, v54
    v_fmac_f32 v15, v54, v54
    v_add_f32 v14, v14, v55
    v_fmac_f32 v15, v55, v55
    v_lshlrev_b32 v48, 16, v180
    v_and_b32 v49, 0xffff0000, v180
    v_add_f32 v14, v14, v48
    v_fmac_f32 v15, v48, v48
    v_add_f32 v14, v14, v49
    s_waitcnt lgkmcnt(12)
    v_mfma_f32_32x32x16_bf16 v[80:95], v[72:75], v[184:187], v[80:95]
    v_add_u32 v17, 0x10000, v17
    ds_read_b64_tr_b16 v[72:73], v17 offset:32768
    ds_read_b64_tr_b16 v[74:75], v17 offset:33280
    s_add_u32 m0, s49, 49152
    s_add_u32 s56, s76, 128
    buffer_load_dwordx4 v4, s[12:15], s56 offen lds
    v_fmac_f32 v15, v49, v49
    v_lshlrev_b32 v50, 16, v181
    v_and_b32 v51, 0xffff0000, v181
    v_add_f32 v14, v14, v50
    v_fmac_f32 v15, v50, v50
    v_add_f32 v14, v14, v51
    v_fmac_f32 v15, v51, v51
    v_lshlrev_b32 v52, 16, v182
    v_and_b32 v53, 0xffff0000, v182
    v_add_f32 v14, v14, v52
    s_waitcnt lgkmcnt(12)
    v_mfma_f32_32x32x16_bf16 v[80:95], v[76:79], v[188:191], v[80:95]
    ds_read_b64_tr_b16 v[76:77], v17 offset:34816
    ds_read_b64_tr_b16 v[78:79], v17 offset:35328
    s_add_u32 m0, s49, 139264
    s_add_u32 s56, s72, 256
    buffer_load_dwordx4 v4, s[12:15], s56 offen lds
    v_fmac_f32 v15, v52, v52
    v_add_f32 v14, v14, v53
    v_fmac_f32 v15, v53, v53
    v_lshlrev_b32 v54, 16, v183
    v_and_b32 v55, 0xffff0000, v183
    v_add_f32 v14, v14, v54
    v_fmac_f32 v15, v54, v54
    v_add_f32 v14, v14, v55
    v_fmac_f32 v15, v55, v55
    s_waitcnt vmcnt(11)
    s_waitcnt vmcnt(10)
    s_barrier
    ds_read_b128 v[208:211], v8 offset:16384
    ds_read_b128 v[212:215], v9 offset:16384
    ds_read_b128 v[216:219], v10 offset:16384
    ds_read_b128 v[220:223], v11 offset:16384
    v_mov_b32 v34, 0
    buffer_load_dwordx2 v[32:33], v34, s[40:43], 0 offen sc1
    s_waitcnt lgkmcnt(15)
    s_waitcnt lgkmcnt(12)
    v_mfma_f32_32x32x16_bf16 v[80:95], v[64:67], v[192:195], v[80:95]
    ds_read_b64_tr_b16 v[64:65], v16 offset:40960
    ds_read_b64_tr_b16 v[66:67], v16 offset:41472
    s_add_u32 m0, s49, 32768
    s_add_u32 s56, s74, 128
    buffer_load_dwordx4 v4, s[12:15], s56 offen lds
    v_lshlrev_b32 v48, 16, v192
    v_and_b32 v49, 0xffff0000, v192
    v_add_f32 v14, v14, v48
    v_fmac_f32 v15, v48, v48
    v_add_f32 v14, v14, v49
    v_fmac_f32 v15, v49, v49
    v_lshlrev_b32 v50, 16, v193
    v_and_b32 v51, 0xffff0000, v193
    v_add_f32 v14, v14, v50
    s_waitcnt lgkmcnt(12)
    v_mfma_f32_32x32x16_bf16 v[80:95], v[68:71], v[196:199], v[80:95]
    ds_read_b64_tr_b16 v[68:69], v16 offset:43008
    ds_read_b64_tr_b16 v[70:71], v16 offset:43520
    s_add_u32 m0, s49, 40960
    s_add_u32 s56, s75, 128
    buffer_load_dwordx4 v4, s[12:15], s56 offen lds
    v_fmac_f32 v15, v50, v50
    v_add_f32 v14, v14, v51
    v_fmac_f32 v15, v51, v51
    v_lshlrev_b32 v52, 16, v194
    v_and_b32 v53, 0xffff0000, v194
    v_add_f32 v14, v14, v52
    v_fmac_f32 v15, v52, v52
    v_add_f32 v14, v14, v53
    v_fmac_f32 v15, v53, v53
    v_lshlrev_b32 v54, 16, v195
    s_waitcnt lgkmcnt(12)
    v_mfma_f32_16x16x32_bf16 v[40:43], v[36:39], v[56:59], v[40:43]
    ds_read_b64_tr_b16 v[56:57], v18 offset:40960
    ds_read_b64_tr_b16 v[58:59], v18 offset:41472
    v_and_b32 v55, 0xffff0000, v195
    v_add_f32 v14, v14, v54
    v_fmac_f32 v15, v54, v54
    v_add_f32 v14, v14, v55
    v_fmac_f32 v15, v55, v55
    v_lshlrev_b32 v48, 16, v196
    v_and_b32 v49, 0xffff0000, v196
    v_add_f32 v14, v14, v48
    v_fmac_f32 v15, v48, v48
    v_add_f32 v14, v14, v49
    s_waitcnt lgkmcnt(12)
    v_mfma_f32_32x32x16_bf16 v[80:95], v[72:75], v[200:203], v[80:95]
    ds_read_b64_tr_b16 v[72:73], v17 offset:40960
    ds_read_b64_tr_b16 v[74:75], v17 offset:41472
    s_add_u32 m0, s49, 57344
    s_add_u32 s56, s77, 128
    buffer_load_dwordx4 v4, s[12:15], s56 offen lds
    v_fmac_f32 v15, v49, v49
    v_lshlrev_b32 v50, 16, v197
    v_and_b32 v51, 0xffff0000, v197
    v_add_f32 v14, v14, v50
    v_fmac_f32 v15, v50, v50
    v_add_f32 v14, v14, v51
    v_fmac_f32 v15, v51, v51
    v_lshlrev_b32 v52, 16, v198
    v_and_b32 v53, 0xffff0000, v198
    v_add_f32 v14, v14, v52
    s_waitcnt lgkmcnt(12)
    v_mfma_f32_32x32x16_bf16 v[80:95], v[76:79], v[204:207], v[80:95]
    ds_read_b64_tr_b16 v[76:77], v17 offset:43008
    ds_read_b64_tr_b16 v[78:79], v17 offset:43520
    v_fmac_f32 v15, v52, v52
    v_add_f32 v14, v14, v53
    v_fmac_f32 v15, v53, v53
    v_lshlrev_b32 v54, 16, v199
    v_and_b32 v55, 0xffff0000, v199
    v_add_f32 v14, v14, v54
    v_fmac_f32 v15, v54, v54
    v_add_f32 v14, v14, v55
    v_fmac_f32 v15, v55, v55
    s_waitcnt vmcnt(12)
    s_waitcnt vmcnt(11)
    s_barrier
    ds_read_b128 v[224:227], v8 offset:49152
    ds_read_b128 v[228:231], v9 offset:49152
    ds_read_b128 v[232:235], v10 offset:49152
    ds_read_b128 v[236:239], v11 offset:49152
    s_waitcnt lgkmcnt(15)
    s_waitcnt lgkmcnt(12)
    v_mfma_f32_32x32x16_bf16 v[80:95], v[64:67], v[208:211], v[80:95]
    v_add_u32 v16, 0x10000, v16
    ds_read_b64_tr_b16 v[64:65], v16 offset:16384
    ds_read_b64_tr_b16 v[66:67], v16 offset:16896
    s_add_u32 m0, s49, 65536
    s_add_u32 s56, s78, 128
    buffer_load_dwordx4 v4, s[12:15], s56 offen lds
    v_lshlrev_b32 v48, 16, v208
    v_and_b32 v49, 0xffff0000, v208
    v_add_f32 v14, v14, v48
    v_fmac_f32 v15, v48, v48
    v_add_f32 v14, v14, v49
    v_fmac_f32 v15, v49, v49
    v_lshlrev_b32 v50, 16, v209
    v_and_b32 v51, 0xffff0000, v209
    v_add_f32 v14, v14, v50
    s_waitcnt lgkmcnt(12)
    v_mfma_f32_32x32x16_bf16 v[80:95], v[68:71], v[212:215], v[80:95]
    ds_read_b64_tr_b16 v[68:69], v16 offset:18432
    ds_read_b64_tr_b16 v[70:71], v16 offset:18944
    s_add_u32 m0, s49, 73728
    s_add_u32 s56, s79, 128
    buffer_load_dwordx4 v4, s[12:15], s56 offen lds
    v_fmac_f32 v15, v50, v50
    v_add_f32 v14, v14, v51
    v_fmac_f32 v15, v51, v51
    v_lshlrev_b32 v52, 16, v210
    v_and_b32 v53, 0xffff0000, v210
    v_add_f32 v14, v14, v52
    v_fmac_f32 v15, v52, v52
    v_add_f32 v14, v14, v53
    v_fmac_f32 v15, v53, v53
    v_lshlrev_b32 v54, 16, v211
    s_waitcnt lgkmcnt(12)
    v_mfma_f32_16x16x32_bf16 v[40:43], v[36:39], v[56:59], v[40:43]
    v_add_u32 v18, 0x10000, v18
    ds_read_b64_tr_b16 v[56:57], v18 offset:16384
    ds_read_b64_tr_b16 v[58:59], v18 offset:16896
    v_and_b32 v55, 0xffff0000, v211
    v_add_f32 v14, v14, v54
    v_fmac_f32 v15, v54, v54
    v_add_f32 v14, v14, v55
    v_fmac_f32 v15, v55, v55
    v_lshlrev_b32 v48, 16, v212
    v_and_b32 v49, 0xffff0000, v212
    v_add_f32 v14, v14, v48
    v_fmac_f32 v15, v48, v48
    v_add_f32 v14, v14, v49
    s_waitcnt lgkmcnt(12)
    v_mfma_f32_32x32x16_bf16 v[80:95], v[72:75], v[216:219], v[80:95]
    v_add_u32 v17, 0x10000, v17
    ds_read_b64_tr_b16 v[72:73], v17 offset:16384
    ds_read_b64_tr_b16 v[74:75], v17 offset:16896
    s_add_u32 m0, s49, 98304
    s_add_u32 s56, s73, 256
    buffer_load_dwordx4 v4, s[12:15], s56 offen lds
    v_fmac_f32 v15, v49, v49
    v_lshlrev_b32 v50, 16, v213
    v_and_b32 v51, 0xffff0000, v213
    v_add_f32 v14, v14, v50
    v_fmac_f32 v15, v50, v50
    v_add_f32 v14, v14, v51
    v_fmac_f32 v15, v51, v51
    v_lshlrev_b32 v52, 16, v214
    v_and_b32 v53, 0xffff0000, v214
    v_add_f32 v14, v14, v52
    s_waitcnt lgkmcnt(12)
    v_mfma_f32_32x32x16_bf16 v[80:95], v[76:79], v[220:223], v[80:95]
    ds_read_b64_tr_b16 v[76:77], v17 offset:18432
    ds_read_b64_tr_b16 v[78:79], v17 offset:18944
    v_fmac_f32 v15, v52, v52
    v_add_f32 v14, v14, v53
    v_fmac_f32 v15, v53, v53
    v_lshlrev_b32 v54, 16, v215
    v_and_b32 v55, 0xffff0000, v215
    v_add_f32 v14, v14, v54
    v_fmac_f32 v15, v54, v54
    v_add_f32 v14, v14, v55
    v_fmac_f32 v15, v55, v55
    s_waitcnt vmcnt(12)
    s_waitcnt vmcnt(11)
    s_barrier
    v_add_u32 v8, 0xffff0000, v8
    ds_read_b128 v[240:243], v8 offset:0
    v_add_u32 v9, 0xffff0000, v9
    ds_read_b128 v[244:247], v9 offset:0
    v_add_u32 v10, 0xffff0000, v10
    ds_read_b128 v[248:251], v10 offset:0
    v_add_u32 v11, 0xffff0000, v11
    ds_read_b128 v[252:255], v11 offset:0
    s_waitcnt lgkmcnt(15)
    s_waitcnt lgkmcnt(12)
    v_mfma_f32_32x32x16_bf16 v[80:95], v[64:67], v[224:227], v[80:95]
    ds_read_b64_tr_b16 v[64:65], v16 offset:0
    ds_read_b64_tr_b16 v[66:67], v16 offset:512
    s_add_u32 m0, s49, 81920
    s_add_u32 s56, s74, 256
    buffer_load_dwordx4 v4, s[12:15], s56 offen lds
    v_lshlrev_b32 v48, 16, v224
    v_and_b32 v49, 0xffff0000, v224
    v_add_f32 v14, v14, v48
    v_fmac_f32 v15, v48, v48
    v_add_f32 v14, v14, v49
    v_fmac_f32 v15, v49, v49
    v_lshlrev_b32 v50, 16, v225
    v_and_b32 v51, 0xffff0000, v225
    v_add_f32 v14, v14, v50
    s_waitcnt lgkmcnt(12)
    v_mfma_f32_32x32x16_bf16 v[80:95], v[68:71], v[228:231], v[80:95]
    ds_read_b64_tr_b16 v[68:69], v16 offset:2048
    ds_read_b64_tr_b16 v[70:71], v16 offset:2560
    s_add_u32 m0, s49, 90112
    s_add_u32 s56, s75, 256
    buffer_load_dwordx4 v4, s[12:15], s56 offen lds
    v_fmac_f32 v15, v50, v50
    v_add_f32 v14, v14, v51
    v_fmac_f32 v15, v51, v51
    v_lshlrev_b32 v52, 16, v226
    v_and_b32 v53, 0xffff0000, v226
    v_add_f32 v14, v14, v52
    v_fmac_f32 v15, v52, v52
    v_add_f32 v14, v14, v53
    v_fmac_f32 v15, v53, v53
    v_lshlrev_b32 v54, 16, v227
    s_waitcnt lgkmcnt(12)
    v_mfma_f32_16x16x32_bf16 v[40:43], v[36:39], v[56:59], v[40:43]
    ds_read_b64_tr_b16 v[56:57], v18 offset:0
    ds_read_b64_tr_b16 v[58:59], v18 offset:512
    v_and_b32 v55, 0xffff0000, v227
    v_add_f32 v14, v14, v54
    v_fmac_f32 v15, v54, v54
    v_add_f32 v14, v14, v55
    v_fmac_f32 v15, v55, v55
    v_lshlrev_b32 v48, 16, v228
    v_and_b32 v49, 0xffff0000, v228
    v_add_f32 v14, v14, v48
    v_fmac_f32 v15, v48, v48
    v_add_f32 v14, v14, v49
    s_waitcnt lgkmcnt(12)
    v_mfma_f32_32x32x16_bf16 v[80:95], v[72:75], v[232:235], v[80:95]
    ds_read_b64_tr_b16 v[72:73], v17 offset:0
    ds_read_b64_tr_b16 v[74:75], v17 offset:512
    s_add_u32 m0, s49, 106496
    s_add_u32 s56, s76, 256
    buffer_load_dwordx4 v4, s[12:15], s56 offen lds
    v_fmac_f32 v15, v49, v49
    v_lshlrev_b32 v50, 16, v229
    v_and_b32 v51, 0xffff0000, v229
    v_add_f32 v14, v14, v50
    v_fmac_f32 v15, v50, v50
    v_add_f32 v14, v14, v51
    v_fmac_f32 v15, v51, v51
    v_lshlrev_b32 v52, 16, v230
    v_and_b32 v53, 0xffff0000, v230
    v_add_f32 v14, v14, v52
    s_waitcnt lgkmcnt(12)
    v_mfma_f32_32x32x16_bf16 v[80:95], v[76:79], v[236:239], v[80:95]
    ds_read_b64_tr_b16 v[76:77], v17 offset:2048
    ds_read_b64_tr_b16 v[78:79], v17 offset:2560
    v_fmac_f32 v15, v52, v52
    v_add_f32 v14, v14, v53
    v_fmac_f32 v15, v53, v53
    v_lshlrev_b32 v54, 16, v231
    v_and_b32 v55, 0xffff0000, v231
    v_add_f32 v14, v14, v54
    v_fmac_f32 v15, v54, v54
    v_add_f32 v14, v14, v55
    v_fmac_f32 v15, v55, v55
    s_waitcnt lgkmcnt(13)
    s_waitcnt lgkmcnt(8)
    v_mfma_f32_32x32x16_bf16 v[80:95], v[64:67], v[240:243], v[80:95]
    v_lshlrev_b32 v48, 16, v240
    v_and_b32 v49, 0xffff0000, v240
    v_add_f32 v14, v14, v48
    v_fmac_f32 v15, v48, v48
    v_add_f32 v14, v14, v49
    v_fmac_f32 v15, v49, v49
    v_lshlrev_b32 v50, 16, v241
    v_and_b32 v51, 0xffff0000, v241
    v_add_f32 v14, v14, v50
    s_waitcnt lgkmcnt(6)
    v_mfma_f32_32x32x16_bf16 v[80:95], v[68:71], v[244:247], v[80:95]
    v_fmac_f32 v15, v50, v50
    v_add_f32 v14, v14, v51
    v_fmac_f32 v15, v51, v51
    v_lshlrev_b32 v52, 16, v242
    v_and_b32 v53, 0xffff0000, v242
    v_add_f32 v14, v14, v52
    v_fmac_f32 v15, v52, v52
    v_add_f32 v14, v14, v53
    v_fmac_f32 v15, v53, v53
    v_lshlrev_b32 v54, 16, v243
    s_waitcnt lgkmcnt(4)
    v_mfma_f32_16x16x32_bf16 v[40:43], v[36:39], v[56:59], v[40:43]
    v_and_b32 v55, 0xffff0000, v243
    v_add_f32 v14, v14, v54
    v_fmac_f32 v15, v54, v54
    v_add_f32 v14, v14, v55
    v_fmac_f32 v15, v55, v55
    v_lshlrev_b32 v48, 16, v244
    v_and_b32 v49, 0xffff0000, v244
    v_add_f32 v14, v14, v48
    v_fmac_f32 v15, v48, v48
    v_add_f32 v14, v14, v49
    s_waitcnt lgkmcnt(2)
    v_mfma_f32_32x32x16_bf16 v[80:95], v[72:75], v[248:251], v[80:95]
    v_fmac_f32 v15, v49, v49
    v_lshlrev_b32 v50, 16, v245
    v_and_b32 v51, 0xffff0000, v245
    v_add_f32 v14, v14, v50
    v_fmac_f32 v15, v50, v50
    v_add_f32 v14, v14, v51
    v_fmac_f32 v15, v51, v51
    v_lshlrev_b32 v52, 16, v246
    v_and_b32 v53, 0xffff0000, v246
    v_add_f32 v14, v14, v52
    s_waitcnt lgkmcnt(0)
    v_mfma_f32_32x32x16_bf16 v[80:95], v[76:79], v[252:255], v[80:95]
    v_fmac_f32 v15, v52, v52
    v_add_f32 v14, v14, v53
    v_fmac_f32 v15, v53, v53
    v_lshlrev_b32 v54, 16, v247
    v_and_b32 v55, 0xffff0000, v247
    v_add_f32 v14, v14, v54
    v_fmac_f32 v15, v54, v54
    v_add_f32 v14, v14, v55
    v_fmac_f32 v15, v55, v55
    s_lshr_b32 s56, s2, 3
    s_lshl_b32 s56, s56, 3
    s_add_u32 s56, s56, s44
    s_mul_i32 s57, s56, 7168
    s_lshl_b32 s56, s56, 11
    v_min_u32 v19, 55, v1
    v_lshlrev_b32 v19, 7, v19
    buffer_load_dword v19, v19, s[20:23], s57 offen
    v_and_b32 v20, 15, v1
    v_lshlrev_b32 v20, 7, v20
    buffer_load_dword v20, v20, s[24:27], s56 offen
    v_and_b32 v48, 31, v1
    v_lshlrev_b32 v48, 5, v48
    s_lshl_b32 s56, s45, 10
    s_add_u32 s56, s56, 155648
    v_add_u32 v48, s56, v48
    v_lshrrev_b32 v49, 5, v1
    v_lshl_add_u32 v49, v49, 3, v48
    s_lshl_b32 s56, s46, 4
    v_add_u32 v49, s56, v49
    ds_write_b64 v49, v[14:15]
    s_mov_b32 exec_hi, 0
    ds_write_b32 v30, v40 offset:0
    s_mov_b32 exec_hi, -1
    s_waitcnt vmcnt(11)
    s_mov_b32 s57, 8000
L_np0:
    v_readfirstlane_b32 s56, v32
    s_nop 0
    s_cmp_lg_u32 s56, 0
    s_cbranch_scc1 L_np0x
    s_sleep 2
    buffer_load_dwordx2 v[32:33], v34, s[40:43], 0 offen sc1
    s_waitcnt vmcnt(0)
    s_sub_u32 s57, s57, 1
    s_cmp_lg_u32 s57, 0
    s_cbranch_scc1 L_np0
L_np0x:
    v_readfirstlane_b32 s94, v32
    v_readfirstlane_b32 s95, v33
    s_waitcnt lgkmcnt(0)
    s_waitcnt vmcnt(10)
    s_waitcnt vmcnt(9)
    s_waitcnt vmcnt(8)
    s_waitcnt vmcnt(7)
    s_waitcnt vmcnt(6)
    s_barrier
    ds_read_b128 v[50:53], v48
    ds_read_b128 v[54:57], v48 offset:16
    s_waitcnt lgkmcnt(0)
    v_add_f32 v50, v50, v52
    v_add_f32 v54, v54, v56
    v_add_f32 v51, v51, v53
    v_add_f32 v55, v55, v57
    v_add_f32 v50, v50, v54
    v_add_f32 v51, v51, v55
    v_mul_f32 v50, 0xbb000000, v50
    v_mul_f32 v51, 0x3b000000, v51
    v_fma_f32 v51, -v50, v50, v51
    v_max_f32 v51, 0, v51
    v_add_f32 v51, 0x3727c5ac, v51
    v_sqrt_f32 v24, v51
    s_nop 0
    v_rcp_f32 v55, v24
    s_nop 0
    v_mul_f32 v26, 0x3fb8aa3b, v55
    v_mul_f32 v22, 0xc0135761, v55
    v_mul_f32 v23, v55, v55
    v_mul_f32 v23, v23, v55
    v_mul_f32 v23, 0xbdd2d3e8, v23
    v_cvt_pk_bf16_f32 v52, v50, v24
    v_lshlrev_b32 v53, 16, v52
    v_and_b32 v54, 0xffff0000, v52
    v_sub_f32 v55, v50, v53
    v_sub_f32 v56, v24, v54
    v_cvt_pk_bf16_f32 v55, v53, v55
    v_cvt_pk_bf16_f32 v56, v56, 0
    v_cmp_gt_u32 vcc, 32, v1
    s_nop 1
    v_cndmask_b32 v32, 0, v55, vcc
    v_cndmask_b32 v33, 0, v52, vcc
    v_cndmask_b32 v34, 0, v56, vcc
    v_mov_b32 v35, 0
    v_add_u32 v16, 0xfffe0000, v16
    ds_read_b64_tr_b16 v[64:65], v16 offset:16384
    ds_read_b64_tr_b16 v[66:67], v16 offset:16896
    ds_read_b64_tr_b16 v[68:69], v16 offset:18432
    ds_read_b64_tr_b16 v[70:71], v16 offset:18944
    v_add_u32 v17, 0xfffe0000, v17
    ds_read_b64_tr_b16 v[72:73], v17 offset:16384
    ds_read_b64_tr_b16 v[74:75], v17 offset:16896
    ds_read_b64_tr_b16 v[76:77], v17 offset:18432
    ds_read_b64_tr_b16 v[78:79], v17 offset:18944
    v_add_u32 v18, 0xfffe0000, v18
    ds_read_b64_tr_b16 v[44:45], v18 offset:16384
    ds_read_b64_tr_b16 v[46:47], v18 offset:16896
    ds_read_b128 v[48:51], v31 offset:0
    s_add_u32 m0, s49, 114688
    s_add_u32 s56, s77, 256
    buffer_load_dwordx4 v4, s[12:15], s56 offen lds
    s_waitcnt lgkmcnt(9)
    v_mfma_f32_32x32x16_bf16 v[96:111], v[64:67], v[128:131], 0
    ds_read_b64_tr_b16 v[64:65], v16 offset:24576
    ds_read_b64_tr_b16 v[66:67], v16 offset:25088
    s_waitcnt lgkmcnt(2)
    v_add_f32 v48, v48, v49
    v_add_f32 v50, v50, v51
    v_mfma_f32_32x32x16_bf16 v[96:111], v[68:71], v[132:135], v[96:111]
    ds_read_b64_tr_b16 v[68:69], v16 offset:26624
    ds_read_b64_tr_b16 v[70:71], v16 offset:27136
    v_add_f32 v48, v48, v50
    v_cvt_pk_bf16_f32 v52, v48, v48
    v_lshlrev_b32 v49, 16, v52
    v_sub_f32 v48, v48, v49
    v_lshlrev_b32 v49, 16, v27
    v_mfma_f32_32x32x16_bf16 v[96:111], v[72:75], v[136:139], v[96:111]
    ds_read_b64_tr_b16 v[72:73], v17 offset:24576
    ds_read_b64_tr_b16 v[74:75], v17 offset:25088
    v_cvt_pk_bf16_f32 v53, v48, v49
    v_mov_b32 v54, v27
    v_mov_b32 v55, 0
    v_mfma_f32_16x16x32_bf16 v[40:43], v[36:39], v[44:47], 0
    ds_read_b64_tr_b16 v[44:45], v18 offset:24576
    ds_read_b64_tr_b16 v[46:47], v18 offset:25088
    v_mfma_f32_32x32x16_bf16 v[80:95], v[52:55], v[32:35], v[80:95]
    v_mfma_f32_32x32x16_bf16 v[96:111], v[76:79], v[140:143], v[96:111]
    ds_read_b64_tr_b16 v[76:77], v17 offset:26624
    ds_read_b64_tr_b16 v[78:79], v17 offset:27136
    s_waitcnt lgkmcnt(8)
    v_mfma_f32_32x32x16_bf16 v[96:111], v[64:67], v[144:147], v[96:111]
    ds_read_b64_tr_b16 v[64:65], v16 offset:32768
    ds_read_b64_tr_b16 v[66:67], v16 offset:33280
    s_nop 4
    v_mul_f32 v56, v80, v80
    v_fma_f32 v56, v56, v23, v22
    v_mul_f32 v57, v81, v81
    v_mul_f32 v56, v56, v80
    s_waitcnt lgkmcnt(8)
    v_mfma_f32_32x32x16_bf16 v[96:111], v[68:71], v[148:151], v[96:111]
    ds_read_b64_tr_b16 v[68:69], v16 offset:34816
    ds_read_b64_tr_b16 v[70:71], v16 offset:35328
    v_fma_f32 v57, v57, v23, v22
    v_mul_f32 v58, v82, v82
    v_exp_f32 v56, v56
    s_waitcnt lgkmcnt(8)
    v_mfma_f32_32x32x16_bf16 v[96:111], v[72:75], v[152:155], v[96:111]
    ds_read_b64_tr_b16 v[72:73], v17 offset:32768
    ds_read_b64_tr_b16 v[74:75], v17 offset:33280
    v_mul_f32 v57, v57, v81
    v_fma_f32 v58, v58, v23, v22
    v_mul_f32 v59, v83, v83
    v_fma_f32 v56, v56, v24, v24
    v_exp_f32 v57, v57
    s_waitcnt lgkmcnt(8)
    v_mfma_f32_16x16x32_bf16 v[40:43], v[36:39], v[44:47], v[40:43]
    ds_read_b64_tr_b16 v[44:45], v18 offset:32768
    ds_read_b64_tr_b16 v[46:47], v18 offset:33280
    v_mul_f32 v58, v58, v82
    v_fma_f32 v59, v59, v23, v22
    v_mul_f32 v60, v84, v84
    v_rcp_f32 v56, v56
    s_add_u32 m0, s49, 122880
    s_add_u32 s56, s78, 256
    buffer_load_dwordx4 v4, s[12:15], s56 offen lds
    s_waitcnt lgkmcnt(8)
    v_mfma_f32_32x32x16_bf16 v[96:111], v[76:79], v[156:159], v[96:111]
    ds_read_b64_tr_b16 v[76:77], v17 offset:34816
    ds_read_b64_tr_b16 v[78:79], v17 offset:35328
    v_fma_f32 v57, v57, v24, v24
    v_exp_f32 v58, v58
    v_mul_f32 v59, v59, v83
    s_waitcnt lgkmcnt(8)
    v_mfma_f32_32x32x16_bf16 v[96:111], v[64:67], v[160:163], v[96:111]
    ds_read_b64_tr_b16 v[64:65], v16 offset:40960
    ds_read_b64_tr_b16 v[66:67], v16 offset:41472
    v_fma_f32 v60, v60, v23, v22
    v_mul_f32 v61, v85, v85
    v_mul_f32 v80, v56, v80
    v_rcp_f32 v57, v57
    s_waitcnt lgkmcnt(8)
    v_mfma_f32_32x32x16_bf16 v[96:111], v[68:71], v[164:167], v[96:111]
    ds_read_b64_tr_b16 v[68:69], v16 offset:43008
    ds_read_b64_tr_b16 v[70:71], v16 offset:43520
    v_fma_f32 v58, v58, v24, v24
    v_exp_f32 v59, v59
    v_mul_f32 v60, v60, v84
    v_fma_f32 v61, v61, v23, v22
    s_waitcnt lgkmcnt(8)
    v_mfma_f32_32x32x16_bf16 v[96:111], v[72:75], v[168:171], v[96:111]
    ds_read_b64_tr_b16 v[72:73], v17 offset:40960
    ds_read_b64_tr_b16 v[74:75], v17 offset:41472
    v_mul_f32 v62, v86, v86
    v_mul_f32 v81, v57, v81
    v_rcp_f32 v58, v58
    v_fma_f32 v59, v59, v24, v24
    s_waitcnt lgkmcnt(8)
    v_mfma_f32_16x16x32_bf16 v[40:43], v[36:39], v[44:47], v[40:43]
    ds_read_b64_tr_b16 v[44:45], v18 offset:40960
    ds_read_b64_tr_b16 v[46:47], v18 offset:41472
    v_exp_f32 v60, v60
    v_mul_f32 v61, v61, v85
    v_fma_f32 v62, v62, v23, v22
    v_mul_f32 v63, v87, v87
    s_waitcnt lgkmcnt(8)
    v_mfma_f32_32x32x16_bf16 v[96:111], v[76:79], v[172:175], v[96:111]
    ds_read_b64_tr_b16 v[76:77], v17 offset:43008
    ds_read_b64_tr_b16 v[78:79], v17 offset:43520
    v_cvt_pk_bf16_f32 v48, v80, v81
    v_mul_f32 v82, v58, v82
    v_rcp_f32 v59, v59
    s_waitcnt lgkmcnt(8)
    v_mfma_f32_32x32x16_bf16 v[96:111], v[64:67], v[176:179], v[96:111]
    ds_read_b64_tr_b16 v[64:65], v16 offset:49152
    ds_read_b64_tr_b16 v[66:67], v16 offset:49664
    v_fma_f32 v60, v60, v24, v24
    v_exp_f32 v61, v61
    v_mul_f32 v62, v62, v86
    v_fma_f32 v63, v63, v23, v22
    s_waitcnt lgkmcnt(8)
    v_mfma_f32_32x32x16_bf16 v[96:111], v[68:71], v[180:183], v[96:111]
    ds_read_b64_tr_b16 v[68:69], v16 offset:51200
    ds_read_b64_tr_b16 v[70:71], v16 offset:51712
    v_mul_f32 v56, v88, v88
    v_mul_f32 v83, v59, v83
    v_rcp_f32 v60, v60
    v_fma_f32 v61, v61, v24, v24
    s_waitcnt lgkmcnt(8)
    v_mfma_f32_32x32x16_bf16 v[96:111], v[72:75], v[184:187], v[96:111]
    ds_read_b64_tr_b16 v[72:73], v17 offset:49152
    ds_read_b64_tr_b16 v[74:75], v17 offset:49664
    v_exp_f32 v62, v62
    v_mul_f32 v63, v63, v87
    v_fma_f32 v56, v56, v23, v22
    v_mul_f32 v57, v89, v89
    s_waitcnt lgkmcnt(8)
    v_mfma_f32_16x16x32_bf16 v[40:43], v[36:39], v[44:47], v[40:43]
    ds_read_b64_tr_b16 v[44:45], v18 offset:49152
    ds_read_b64_tr_b16 v[46:47], v18 offset:49664
    v_cvt_pk_bf16_f32 v49, v82, v83
    v_mul_f32 v84, v60, v84
    v_rcp_f32 v61, v61
    v_fma_f32 v62, v62, v24, v24
    s_add_u32 m0, s49, 147456
    s_add_u32 s56, s79, 256
    buffer_load_dwordx4 v4, s[12:15], s56 offen lds
    s_waitcnt lgkmcnt(8)
    v_mfma_f32_32x32x16_bf16 v[96:111], v[76:79], v[188:191], v[96:111]
    ds_read_b64_tr_b16 v[76:77], v17 offset:51200
    ds_read_b64_tr_b16 v[78:79], v17 offset:51712
    v_exp_f32 v63, v63
    v_mul_f32 v56, v56, v88
    v_fma_f32 v57, v57, v23, v22
    v_mul_f32 v58, v90, v90
    s_waitcnt lgkmcnt(8)
    v_mfma_f32_32x32x16_bf16 v[96:111], v[64:67], v[192:195], v[96:111]
    ds_read_b64_tr_b16 v[64:65], v16 offset:57344
    ds_read_b64_tr_b16 v[66:67], v16 offset:57856
    v_mul_f32 v85, v61, v85
    v_rcp_f32 v62, v62
    v_fma_f32 v63, v63, v24, v24
    v_exp_f32 v56, v56
    s_waitcnt lgkmcnt(8)
    v_mfma_f32_32x32x16_bf16 v[96:111], v[68:71], v[196:199], v[96:111]
    ds_read_b64_tr_b16 v[68:69], v16 offset:59392
    ds_read_b64_tr_b16 v[70:71], v16 offset:59904
    v_mul_f32 v57, v57, v89
    v_fma_f32 v58, v58, v23, v22
    v_mul_f32 v59, v91, v91
    s_waitcnt lgkmcnt(8)
    v_mfma_f32_32x32x16_bf16 v[96:111], v[72:75], v[200:203], v[96:111]
    ds_read_b64_tr_b16 v[72:73], v17 offset:57344
    ds_read_b64_tr_b16 v[74:75], v17 offset:57856
    v_cvt_pk_bf16_f32 v50, v84, v85
    v_mul_f32 v86, v62, v86
    v_rcp_f32 v63, v63
    v_fma_f32 v56, v56, v24, v24
    s_waitcnt lgkmcnt(8)
    v_mfma_f32_16x16x32_bf16 v[40:43], v[36:39], v[44:47], v[40:43]
    ds_read_b64_tr_b16 v[44:45], v18 offset:57344
    ds_read_b64_tr_b16 v[46:47], v18 offset:57856
    v_exp_f32 v57, v57
    v_mul_f32 v58, v58, v90
    v_fma_f32 v59, v59, v23, v22
    v_mul_f32 v60, v92, v92
    s_waitcnt lgkmcnt(8)
    v_mfma_f32_32x32x16_bf16 v[96:111], v[76:79], v[204:207], v[96:111]
    ds_read_b64_tr_b16 v[76:77], v17 offset:59392
    ds_read_b64_tr_b16 v[78:79], v17 offset:59904
    v_mul_f32 v87, v63, v87
    v_rcp_f32 v56, v56
    v_fma_f32 v57, v57, v24, v24
    v_exp_f32 v58, v58
    s_waitcnt lgkmcnt(8)
    v_mfma_f32_32x32x16_bf16 v[96:111], v[64:67], v[208:211], v[96:111]
    v_add_u32 v16, 0x10000, v16
    ds_read_b64_tr_b16 v[64:65], v16 offset:0
    ds_read_b64_tr_b16 v[66:67], v16 offset:512
    v_mul_f32 v59, v59, v91
    v_fma_f32 v60, v60, v23, v22
    v_mul_f32 v61, v93, v93
    v_cvt_pk_bf16_f32 v51, v86, v87
    s_waitcnt lgkmcnt(8)
    v_mfma_f32_32x32x16_bf16 v[96:111], v[68:71], v[212:215], v[96:111]
    ds_read_b64_tr_b16 v[68:69], v16 offset:2048
    ds_read_b64_tr_b16 v[70:71], v16 offset:2560
    s_add_u32 s58, s54, 0
    buffer_store_dwordx4 v[48:51], v6, s[16:19], s58 offen sc1
    v_mul_f32 v88, v56, v88
    v_rcp_f32 v57, v57
    v_fma_f32 v58, v58, v24, v24
    s_waitcnt lgkmcnt(8)
    v_mfma_f32_32x32x16_bf16 v[96:111], v[72:75], v[216:219], v[96:111]
    v_add_u32 v17, 0x10000, v17
    ds_read_b64_tr_b16 v[72:73], v17 offset:0
    ds_read_b64_tr_b16 v[74:75], v17 offset:512
    v_exp_f32 v59, v59
    v_mul_f32 v60, v60, v92
    v_fma_f32 v61, v61, v23, v22
    v_mul_f32 v62, v94, v94
    s_add_u32 m0, s50, 0
    s_mul_i32 s56, s44, 196608
    s_add_u32 s56, s56, s62
    s_add_u32 s56, s56, 0
    buffer_load_dwordx4 v7, s[20:23], s56 offen lds
    buffer_load_dwordx4 v0, s[20:23], s56 offen offset:1024 lds
    s_waitcnt lgkmcnt(8)
    v_mfma_f32_16x16x32_bf16 v[40:43], v[36:39], v[44:47], v[40:43]
    v_add_u32 v18, 0x10000, v18
    ds_read_b64_tr_b16 v[44:45], v18 offset:0
    ds_read_b64_tr_b16 v[46:47], v18 offset:512
    v_mul_f32 v89, v57, v89
    v_rcp_f32 v58, v58
    v_fma_f32 v59, v59, v24, v24
    v_exp_f32 v60, v60
    s_waitcnt lgkmcnt(8)
    v_mfma_f32_32x32x16_bf16 v[96:111], v[76:79], v[220:223], v[96:111]
    ds_read_b64_tr_b16 v[76:77], v17 offset:2048
    ds_read_b64_tr_b16 v[78:79], v17 offset:2560
    v_mul_f32 v61, v61, v93
    v_fma_f32 v62, v62, v23, v22
    v_mul_f32 v63, v95, v95
    s_waitcnt lgkmcnt(8)
    v_mfma_f32_32x32x16_bf16 v[96:111], v[64:67], v[224:227], v[96:111]
    ds_read_b64_tr_b16 v[64:65], v16 offset:8192
    ds_read_b64_tr_b16 v[66:67], v16 offset:8704
    v_cvt_pk_bf16_f32 v52, v88, v89
    v_mul_f32 v90, v58, v90
    v_rcp_f32 v59, v59
    v_fma_f32 v60, v60, v24, v24
    s_waitcnt lgkmcnt(8)
    v_mfma_f32_32x32x16_bf16 v[96:111], v[68:71], v[228:231], v[96:111]
    ds_read_b64_tr_b16 v[68:69], v16 offset:10240
    ds_read_b64_tr_b16 v[70:71], v16 offset:10752
    v_exp_f32 v61, v61
    v_mul_f32 v62, v62, v94
    v_fma_f32 v63, v63, v23, v22
    v_mul_f32 v91, v59, v91
    s_waitcnt lgkmcnt(8)
    v_mfma_f32_32x32x16_bf16 v[96:111], v[72:75], v[232:235], v[96:111]
    ds_read_b64_tr_b16 v[72:73], v17 offset:8192
    ds_read_b64_tr_b16 v[74:75], v17 offset:8704
    v_rcp_f32 v60, v60
    v_fma_f32 v61, v61, v24, v24
    v_exp_f32 v62, v62
    s_waitcnt lgkmcnt(8)
    v_mfma_f32_16x16x32_bf16 v[40:43], v[36:39], v[44:47], v[40:43]
    ds_read_b64_tr_b16 v[44:45], v18 offset:8192
    ds_read_b64_tr_b16 v[46:47], v18 offset:8704
    v_mul_f32 v63, v63, v95
    v_cvt_pk_bf16_f32 v53, v90, v91
    v_mul_f32 v92, v60, v92
    v_rcp_f32 v61, v61
    s_waitcnt lgkmcnt(8)
    v_mfma_f32_32x32x16_bf16 v[96:111], v[76:79], v[236:239], v[96:111]
    ds_read_b64_tr_b16 v[76:77], v17 offset:10240
    ds_read_b64_tr_b16 v[78:79], v17 offset:10752
    v_fma_f32 v62, v62, v24, v24
    v_exp_f32 v63, v63
    v_mul_f32 v93, v61, v93
    v_rcp_f32 v62, v62
    s_waitcnt lgkmcnt(8)
    v_mfma_f32_32x32x16_bf16 v[96:111], v[64:67], v[240:243], v[96:111]
    v_fma_f32 v63, v63, v24, v24
    v_cvt_pk_bf16_f32 v54, v92, v93
    v_mul_f32 v94, v62, v94
    v_rcp_f32 v63, v63
    s_waitcnt lgkmcnt(6)
    v_mfma_f32_32x32x16_bf16 v[96:111], v[68:71], v[244:247], v[96:111]
    v_mul_f32 v95, v63, v95
    v_cvt_pk_bf16_f32 v55, v94, v95
    s_add_u32 s58, s54, 1024
    buffer_store_dwordx4 v[52:55], v6, s[16:19], s58 offen sc1
    s_waitcnt lgkmcnt(4)
    v_mfma_f32_32x32x16_bf16 v[96:111], v[72:75], v[248:251], v[96:111]
    s_waitcnt lgkmcnt(2)
    v_mfma_f32_16x16x32_bf16 v[40:43], v[36:39], v[44:47], v[40:43]
    s_waitcnt lgkmcnt(0)
    v_mfma_f32_32x32x16_bf16 v[96:111], v[76:79], v[252:255], v[96:111]
    s_mov_b32 exec_hi, 0
    s_nop 4
    ds_write_b32 v30, v40 offset:1024
    s_mov_b32 exec_hi, -1
    s_waitcnt lgkmcnt(0)
    s_waitcnt vmcnt(12)
    s_waitcnt vmcnt(11)
    s_waitcnt vmcnt(10)
    s_waitcnt vmcnt(9)
    s_waitcnt vmcnt(6)
    s_waitcnt vmcnt(5)
    s_waitcnt vmcnt(4)
    s_barrier
    v_and_b32 v9, 16, v1
    v_lshlrev_b32 v9, 1, v9
    v_and_b32 v10, 3, v1
    v_lshl_add_u32 v9, v10, 3, v9
    v_and_b32 v10, 8, v1
    v_lshl_add_u32 v9, v10, 3, v9
    v_bfe_u32 v10, v1, 2, 2
    v_lshl_add_u32 v9, v10, 7, v9
    v_lshrrev_b32 v10, 5, v1
    v_lshl_add_u32 v9, v10, 9, v9
    v_add_u32 v9, s50, v9
    v_xor_b32 v10, 64, v9
    v_add_u32 v16, 0x10000, v16
    ds_read_b64_tr_b16 v[64:65], v16 offset:8192
    ds_read_b64_tr_b16 v[66:67], v16 offset:8704
    ds_read_b64_tr_b16 v[68:69], v16 offset:10240
    ds_read_b64_tr_b16 v[70:71], v16 offset:10752
    v_add_u32 v17, 0x10000, v17
    ds_read_b64_tr_b16 v[72:73], v17 offset:8192
    ds_read_b64_tr_b16 v[74:75], v17 offset:8704
    ds_read_b64_tr_b16 v[76:77], v17 offset:10240
    ds_read_b64_tr_b16 v[78:79], v17 offset:10752
    v_add_u32 v18, 0x10000, v18
    ds_read_b64_tr_b16 v[44:45], v18 offset:8192
    ds_read_b64_tr_b16 v[46:47], v18 offset:8704
    ds_read_b128 v[48:51], v31 offset:1024
    s_add_u32 m0, s50, 16384
    s_mul_i32 s56, s44, 196608
    s_add_u32 s56, s56, s62
    s_add_u32 s56, s56, 16384
    buffer_load_dwordx4 v7, s[20:23], s56 offen lds
    buffer_load_dwordx4 v0, s[20:23], s56 offen offset:1024 lds
    s_waitcnt lgkmcnt(9)
    v_mfma_f32_32x32x16_bf16 v[80:95], v[64:67], v[128:131], 0
    v_add_u32 v16, 0xffff0000, v16
    ds_read_b64_tr_b16 v[64:65], v16 offset:32768
    ds_read_b64_tr_b16 v[66:67], v16 offset:33280
    s_waitcnt lgkmcnt(2)
    v_add_f32 v48, v48, v49
    v_add_f32 v50, v50, v51
    v_add_f32 v48, v48, v50
    v_cvt_pk_bf16_f32 v52, v48, v48
    v_mfma_f32_32x32x16_bf16 v[80:95], v[68:71], v[132:135], v[80:95]
    ds_read_b64_tr_b16 v[68:69], v16 offset:34816
    ds_read_b64_tr_b16 v[70:71], v16 offset:35328
    v_lshlrev_b32 v49, 16, v52
    v_sub_f32 v48, v48, v49
    v_lshlrev_b32 v49, 16, v28
    v_cvt_pk_bf16_f32 v53, v48, v49
    v_mov_b32 v54, v28
    v_mov_b32 v55, 0
    s_add_u32 m0, s50, 32768
    s_mul_i32 s56, s44, 196608
    s_add_u32 s56, s56, s62
    s_add_u32 s56, s56, 32768
    buffer_load_dwordx4 v7, s[20:23], s56 offen lds
    buffer_load_dwordx4 v0, s[20:23], s56 offen offset:1024 lds
    v_mfma_f32_32x32x16_bf16 v[80:95], v[72:75], v[136:139], v[80:95]
    v_add_u32 v17, 0xffff0000, v17
    ds_read_b64_tr_b16 v[72:73], v17 offset:32768
    ds_read_b64_tr_b16 v[74:75], v17 offset:33280
    v_mfma_f32_32x32x16_bf16 v[96:111], v[52:55], v[32:35], v[96:111]
    v_mfma_f32_16x16x32_bf16 v[40:43], v[36:39], v[44:47], 0
    v_add_u32 v18, 0xffff0000, v18
    ds_read_b64_tr_b16 v[44:45], v18 offset:32768
    ds_read_b64_tr_b16 v[46:47], v18 offset:33280
    v_mfma_f32_32x32x16_bf16 v[80:95], v[76:79], v[140:143], v[80:95]
    ds_read_b64_tr_b16 v[76:77], v17 offset:34816
    ds_read_b64_tr_b16 v[78:79], v17 offset:35328
    s_nop 4
    v_mul_f32 v56, v96, v96
    v_fma_f32 v56, v56, v23, v22
    v_mul_f32 v57, v97, v97
    v_mul_f32 v56, v56, v96
    v_fma_f32 v57, v57, v23, v22
    s_add_u32 m0, s50, 49152
    s_mul_i32 s56, s44, 196608
    s_add_u32 s56, s56, s62
    s_add_u32 s56, s56, 49152
    buffer_load_dwordx4 v7, s[20:23], s56 offen lds
    buffer_load_dwordx4 v0, s[20:23], s56 offen offset:1024 lds
    s_waitcnt lgkmcnt(8)
    v_mfma_f32_32x32x16_bf16 v[80:95], v[64:67], v[144:147], v[80:95]
    ds_read_b64_tr_b16 v[64:65], v16 offset:16384
    ds_read_b64_tr_b16 v[66:67], v16 offset:16896
    v_mul_f32 v58, v98, v98
    v_exp_f32 v56, v56
    v_mul_f32 v57, v57, v97
    v_fma_f32 v58, v58, v23, v22
    v_mul_f32 v59, v99, v99
    s_waitcnt lgkmcnt(8)
    v_mfma_f32_32x32x16_bf16 v[80:95], v[68:71], v[148:151], v[80:95]
    ds_read_b64_tr_b16 v[68:69], v16 offset:18432
    ds_read_b64_tr_b16 v[70:71], v16 offset:18944
    v_fma_f32 v56, v56, v24, v24
    v_exp_f32 v57, v57
    v_mul_f32 v58, v58, v98
    v_fma_f32 v59, v59, v23, v22
    v_mul_f32 v60, v100, v100
    s_waitcnt lgkmcnt(8)
    v_mfma_f32_32x32x16_bf16 v[80:95], v[72:75], v[152:155], v[80:95]
    ds_read_b64_tr_b16 v[72:73], v17 offset:16384
    ds_read_b64_tr_b16 v[74:75], v17 offset:16896
    v_rcp_f32 v56, v56
    v_fma_f32 v57, v57, v24, v24
    v_exp_f32 v58, v58
    v_mul_f32 v59, v59, v99
    s_add_u32 m0, s50, 65536
    s_mul_i32 s56, s44, 196608
    s_add_u32 s56, s56, s62
    s_add_u32 s56, s56, 65536
    buffer_load_dwordx4 v7, s[20:23], s56 offen lds
    buffer_load_dwordx4 v0, s[20:23], s56 offen offset:1024 lds
    s_waitcnt lgkmcnt(8)
    v_mfma_f32_16x16x32_bf16 v[40:43], v[36:39], v[44:47], v[40:43]
    ds_read_b64_tr_b16 v[44:45], v18 offset:16384
    ds_read_b64_tr_b16 v[46:47], v18 offset:16896
    v_fma_f32 v60, v60, v23, v22
    v_mul_f32 v61, v101, v101
    v_mul_f32 v96, v56, v96
    v_rcp_f32 v57, v57
    v_fma_f32 v58, v58, v24, v24
    s_waitcnt lgkmcnt(8)
    v_mfma_f32_32x32x16_bf16 v[80:95], v[76:79], v[156:159], v[80:95]
    ds_read_b64_tr_b16 v[76:77], v17 offset:18432
    ds_read_b64_tr_b16 v[78:79], v17 offset:18944
    v_exp_f32 v59, v59
    v_mul_f32 v60, v60, v100
    v_fma_f32 v61, v61, v23, v22
    v_mul_f32 v62, v102, v102
    v_mul_f32 v97, v57, v97
    s_waitcnt lgkmcnt(8)
    v_mfma_f32_32x32x16_bf16 v[80:95], v[64:67], v[160:163], v[80:95]
    ds_read_b64_tr_b16 v[64:65], v16 offset:24576
    ds_read_b64_tr_b16 v[66:67], v16 offset:25088
    v_rcp_f32 v58, v58
    v_fma_f32 v59, v59, v24, v24
    v_exp_f32 v60, v60
    v_mul_f32 v61, v61, v101
    s_waitcnt lgkmcnt(8)
    v_mfma_f32_32x32x16_bf16 v[80:95], v[68:71], v[164:167], v[80:95]
    ds_read_b64_tr_b16 v[68:69], v16 offset:26624
    ds_read_b64_tr_b16 v[70:71], v16 offset:27136
    v_fma_f32 v62, v62, v23, v22
    v_mul_f32 v63, v103, v103
    v_cvt_pk_bf16_f32 v48, v96, v97
    v_mul_f32 v98, v58, v98
    v_rcp_f32 v59, v59
    s_waitcnt lgkmcnt(8)
    v_mfma_f32_32x32x16_bf16 v[80:95], v[72:75], v[168:171], v[80:95]
    ds_read_b64_tr_b16 v[72:73], v17 offset:24576
    ds_read_b64_tr_b16 v[74:75], v17 offset:25088
    v_fma_f32 v60, v60, v24, v24
    v_exp_f32 v61, v61
    v_mul_f32 v62, v62, v102
    v_fma_f32 v63, v63, v23, v22
    s_waitcnt lgkmcnt(8)
    v_mfma_f32_16x16x32_bf16 v[40:43], v[36:39], v[44:47], v[40:43]
    ds_read_b64_tr_b16 v[44:45], v18 offset:24576
    ds_read_b64_tr_b16 v[46:47], v18 offset:25088
    v_mul_f32 v56, v104, v104
    v_mul_f32 v99, v59, v99
    v_rcp_f32 v60, v60
    v_fma_f32 v61, v61, v24, v24
    v_exp_f32 v62, v62
    s_waitcnt lgkmcnt(8)
    v_mfma_f32_32x32x16_bf16 v[80:95], v[76:79], v[172:175], v[80:95]
    ds_read_b64_tr_b16 v[76:77], v17 offset:26624
    ds_read_b64_tr_b16 v[78:79], v17 offset:27136
    v_mul_f32 v63, v63, v103
    v_fma_f32 v56, v56, v23, v22
    v_mul_f32 v57, v105, v105
    v_cvt_pk_bf16_f32 v49, v98, v99
    v_mul_f32 v100, v60, v100
    s_waitcnt lgkmcnt(8)
    v_mfma_f32_32x32x16_bf16 v[80:95], v[64:67], v[176:179], v[80:95]
    ds_read_b64_tr_b16 v[64:65], v16 offset:40960
    ds_read_b64_tr_b16 v[66:67], v16 offset:41472
    v_rcp_f32 v61, v61
    v_fma_f32 v62, v62, v24, v24
    v_exp_f32 v63, v63
    v_mul_f32 v56, v56, v104
    s_waitcnt vmcnt(9)
    ds_read_b64_tr_b16 v[128:129], v9 offset:0
    ds_read_b64_tr_b16 v[130:131], v9 offset:1024
    ds_read_b64_tr_b16 v[132:133], v10 offset:0
    ds_read_b64_tr_b16 v[134:135], v10 offset:1024
    s_waitcnt lgkmcnt(12)
    v_mfma_f32_32x32x16_bf16 v[80:95], v[68:71], v[180:183], v[80:95]
    ds_read_b64_tr_b16 v[68:69], v16 offset:43008
    ds_read_b64_tr_b16 v[70:71], v16 offset:43520
    v_fma_f32 v57, v57, v23, v22
    v_mul_f32 v58, v106, v106
    v_mul_f32 v101, v61, v101
    v_rcp_f32 v62, v62
    v_fma_f32 v63, v63, v24, v24
    s_waitcnt lgkmcnt(12)
    v_mfma_f32_32x32x16_bf16 v[80:95], v[72:75], v[184:187], v[80:95]
    ds_read_b64_tr_b16 v[72:73], v17 offset:40960
    ds_read_b64_tr_b16 v[74:75], v17 offset:41472
    v_exp_f32 v56, v56
    v_mul_f32 v57, v57, v105
    v_fma_f32 v58, v58, v23, v22
    v_mul_f32 v59, v107, v107
    v_cvt_pk_bf16_f32 v50, v100, v101
    s_waitcnt lgkmcnt(12)
    v_mfma_f32_16x16x32_bf16 v[40:43], v[36:39], v[44:47], v[40:43]
    ds_read_b64_tr_b16 v[44:45], v18 offset:40960
    ds_read_b64_tr_b16 v[46:47], v18 offset:41472
    v_mul_f32 v102, v62, v102
    v_rcp_f32 v63, v63
    v_fma_f32 v56, v56, v24, v24
    v_exp_f32 v57, v57
    s_waitcnt vmcnt(6)
    ds_read_b64_tr_b16 v[136:137], v9 offset:16384
    ds_read_b64_tr_b16 v[138:139], v9 offset:17408
    ds_read_b64_tr_b16 v[140:141], v10 offset:16384
    ds_read_b64_tr_b16 v[142:143], v10 offset:17408
    s_waitcnt lgkmcnt(15)
    v_mfma_f32_32x32x16_bf16 v[80:95], v[76:79], v[188:191], v[80:95]
    ds_read_b64_tr_b16 v[76:77], v17 offset:43008
    ds_read_b64_tr_b16 v[78:79], v17 offset:43520
    v_mul_f32 v58, v58, v106
    v_fma_f32 v59, v59, v23, v22
    v_mul_f32 v60, v108, v108
    v_mul_f32 v103, v63, v103
    v_rcp_f32 v56, v56
    s_waitcnt lgkmcnt(15)
    v_mfma_f32_32x32x16_bf16 v[80:95], v[64:67], v[192:195], v[80:95]
    ds_read_b64_tr_b16 v[64:65], v16 offset:49152
    ds_read_b64_tr_b16 v[66:67], v16 offset:49664
    v_fma_f32 v57, v57, v24, v24
    v_exp_f32 v58, v58
    v_mul_f32 v59, v59, v107
    v_fma_f32 v60, v60, v23, v22
    v_mul_f32 v61, v109, v109
    s_waitcnt lgkmcnt(14)
    s_add_u32 m0, s50, 0
    s_mul_i32 s56, s44, 196608
    s_add_u32 s56, s56, s62
    s_add_u32 s56, s56, 147456
    buffer_load_dwordx4 v7, s[20:23], s56 offen lds
    buffer_load_dwordx4 v0, s[20:23], s56 offen offset:1024 lds
    s_waitcnt lgkmcnt(12)
    v_mfma_f32_32x32x16_bf16 v[80:95], v[68:71], v[196:199], v[80:95]
    ds_read_b64_tr_b16 v[68:69], v16 offset:51200
    ds_read_b64_tr_b16 v[70:71], v16 offset:51712
    v_cvt_pk_bf16_f32 v51, v102, v103
    s_add_u32 s58, s54, 4096
    buffer_store_dwordx4 v[48:51], v6, s[16:19], s58 offen sc1
    v_mul_f32 v104, v56, v104
    v_rcp_f32 v57, v57
    v_fma_f32 v58, v58, v24, v24
    s_waitcnt lgkmcnt(12)
    v_mfma_f32_32x32x16_bf16 v[80:95], v[72:75], v[200:203], v[80:95]
    ds_read_b64_tr_b16 v[72:73], v17 offset:49152
    ds_read_b64_tr_b16 v[74:75], v17 offset:49664
    v_exp_f32 v59, v59
    v_mul_f32 v60, v60, v108
    v_fma_f32 v61, v61, v23, v22
    v_mul_f32 v62, v110, v110
    v_mul_f32 v105, v57, v105
    s_waitcnt vmcnt(7)
    ds_read_b64_tr_b16 v[144:145], v9 offset:32768
    ds_read_b64_tr_b16 v[146:147], v9 offset:33792
    ds_read_b64_tr_b16 v[148:149], v10 offset:32768
    ds_read_b64_tr_b16 v[150:151], v10 offset:33792
    s_waitcnt lgkmcnt(15)
    v_mfma_f32_16x16x32_bf16 v[40:43], v[36:39], v[44:47], v[40:43]
    ds_read_b64_tr_b16 v[44:45], v18 offset:49152
    ds_read_b64_tr_b16 v[46:47], v18 offset:49664
    v_rcp_f32 v58, v58
    v_fma_f32 v59, v59, v24, v24
    v_exp_f32 v60, v60
    v_mul_f32 v61, v61, v109
    s_waitcnt lgkmcnt(12)
    v_mfma_f32_32x32x16_bf16 v[80:95], v[76:79], v[204:207], v[80:95]
    ds_read_b64_tr_b16 v[76:77], v17 offset:51200
    ds_read_b64_tr_b16 v[78:79], v17 offset:51712
    v_fma_f32 v62, v62, v23, v22
    v_mul_f32 v63, v111, v111
    v_cvt_pk_bf16_f32 v52, v104, v105
    v_mul_f32 v106, v58, v106
    v_rcp_f32 v59, v59
    s_add_u32 m0, s50, 16384
    s_mul_i32 s56, s44, 196608
    s_add_u32 s56, s56, s62
    s_add_u32 s56, s56, 163840
    buffer_load_dwordx4 v7, s[20:23], s56 offen lds
    buffer_load_dwordx4 v0, s[20:23], s56 offen offset:1024 lds
    s_waitcnt lgkmcnt(12)
    v_mfma_f32_32x32x16_bf16 v[80:95], v[64:67], v[208:211], v[80:95]
    ds_read_b64_tr_b16 v[64:65], v16 offset:57344
    ds_read_b64_tr_b16 v[66:67], v16 offset:57856
    v_fma_f32 v60, v60, v24, v24
    v_exp_f32 v61, v61
    v_mul_f32 v62, v62, v110
    v_fma_f32 v63, v63, v23, v22
    s_waitcnt lgkmcnt(12)
    v_mfma_f32_32x32x16_bf16 v[80:95], v[68:71], v[212:215], v[80:95]
    ds_read_b64_tr_b16 v[68:69], v16 offset:59392
    ds_read_b64_tr_b16 v[70:71], v16 offset:59904
    v_mul_f32 v107, v59, v107
    v_rcp_f32 v60, v60
    v_fma_f32 v61, v61, v24, v24
    v_exp_f32 v62, v62
    s_waitcnt vmcnt(7)
    ds_read_b64_tr_b16 v[152:153], v9 offset:49152
    ds_read_b64_tr_b16 v[154:155], v9 offset:50176
    ds_read_b64_tr_b16 v[156:157], v10 offset:49152
    ds_read_b64_tr_b16 v[158:159], v10 offset:50176
    s_waitcnt lgkmcnt(15)
    v_mfma_f32_32x32x16_bf16 v[80:95], v[72:75], v[216:219], v[80:95]
    ds_read_b64_tr_b16 v[72:73], v17 offset:57344
    ds_read_b64_tr_b16 v[74:75], v17 offset:57856
    v_mul_f32 v63, v63, v111
    v_cvt_pk_bf16_f32 v53, v106, v107
    v_mul_f32 v108, v60, v108
    v_rcp_f32 v61, v61
    v_fma_f32 v62, v62, v24, v24
    s_waitcnt lgkmcnt(12)
    v_mfma_f32_16x16x32_bf16 v[40:43], v[36:39], v[44:47], v[40:43]
    ds_read_b64_tr_b16 v[44:45], v18 offset:57344
    ds_read_b64_tr_b16 v[46:47], v18 offset:57856
    v_exp_f32 v63, v63
    v_mul_f32 v109, v61, v109
    v_rcp_f32 v62, v62
    v_fma_f32 v63, v63, v24, v24
    s_add_u32 m0, s50, 32768
    s_mul_i32 s56, s44, 196608
    s_add_u32 s56, s56, s62
    s_add_u32 s56, s56, 180224
    buffer_load_dwordx4 v7, s[20:23], s56 offen lds
    buffer_load_dwordx4 v0, s[20:23], s56 offen offset:1024 lds
    s_waitcnt lgkmcnt(12)
    v_mfma_f32_32x32x16_bf16 v[80:95], v[76:79], v[220:223], v[80:95]
    ds_read_b64_tr_b16 v[76:77], v17 offset:59392
    ds_read_b64_tr_b16 v[78:79], v17 offset:59904
    v_cvt_pk_bf16_f32 v54, v108, v109
    v_mul_f32 v110, v62, v110
    v_rcp_f32 v63, v63
    s_nop 0
    v_mul_f32 v111, v63, v111
    v_cvt_pk_bf16_f32 v55, v110, v111
    s_waitcnt lgkmcnt(12)
    v_mfma_f32_32x32x16_bf16 v[80:95], v[64:67], v[224:227], v[80:95]
    v_add_u32 v16, 0x10000, v16
    ds_read_b64_tr_b16 v[64:65], v16 offset:16384
    ds_read_b64_tr_b16 v[66:67], v16 offset:16896
    s_add_u32 s58, s54, 5120
    buffer_store_dwordx4 v[52:55], v6, s[16:19], s58 offen sc1
    s_waitcnt vmcnt(8)
    v_add_u32 v9, 0x10000, v9
    ds_read_b64_tr_b16 v[160:161], v9 offset:0
    ds_read_b64_tr_b16 v[162:163], v9 offset:1024
    v_add_u32 v10, 0x10000, v10
    ds_read_b64_tr_b16 v[164:165], v10 offset:0
    ds_read_b64_tr_b16 v[166:167], v10 offset:1024
    s_waitcnt lgkmcnt(15)
    v_mfma_f32_32x32x16_bf16 v[80:95], v[68:71], v[228:231], v[80:95]
    ds_read_b64_tr_b16 v[68:69], v16 offset:18432
    ds_read_b64_tr_b16 v[70:71], v16 offset:18944
    s_waitcnt lgkmcnt(12)
    v_mfma_f32_32x32x16_bf16 v[80:95], v[72:75], v[232:235], v[80:95]
    v_add_u32 v17, 0x10000, v17
    ds_read_b64_tr_b16 v[72:73], v17 offset:16384
    ds_read_b64_tr_b16 v[74:75], v17 offset:16896
    s_add_u32 m0, s50, 49152
    s_mul_i32 s56, s44, 32768
    s_add_u32 s56, s56, s62
    s_add_u32 s56, s56, 1572864
    buffer_load_dwordx4 v7, s[20:23], s56 offen lds
    buffer_load_dwordx4 v0, s[20:23], s56 offen offset:1024 lds
    s_waitcnt lgkmcnt(12)
    v_mfma_f32_16x16x32_bf16 v[40:43], v[36:39], v[44:47], v[40:43]
    v_add_u32 v18, 0x10000, v18
    ds_read_b64_tr_b16 v[44:45], v18 offset:16384
    ds_read_b64_tr_b16 v[46:47], v18 offset:16896
    s_waitcnt lgkmcnt(12)
    v_mfma_f32_32x32x16_bf16 v[80:95], v[76:79], v[236:239], v[80:95]
    ds_read_b64_tr_b16 v[76:77], v17 offset:18432
    ds_read_b64_tr_b16 v[78:79], v17 offset:18944
    s_waitcnt lgkmcnt(8)
    s_add_u32 m0, s50, 65536
    s_mul_i32 s56, s44, 32768
    s_add_u32 s56, s56, s62
    s_add_u32 s56, s56, 1589248
    buffer_load_dwordx4 v7, s[20:23], s56 offen lds
    buffer_load_dwordx4 v0, s[20:23], s56 offen offset:1024 lds
    v_mfma_f32_32x32x16_bf16 v[80:95], v[64:67], v[240:243], v[80:95]
    s_waitcnt lgkmcnt(6)
    v_mfma_f32_32x32x16_bf16 v[80:95], v[68:71], v[244:247], v[80:95]
    s_waitcnt lgkmcnt(4)
    v_mfma_f32_32x32x16_bf16 v[80:95], v[72:75], v[248:251], v[80:95]
    s_waitcnt lgkmcnt(2)
    v_mfma_f32_16x16x32_bf16 v[40:43], v[36:39], v[44:47], v[40:43]
    s_waitcnt lgkmcnt(0)
    v_mfma_f32_32x32x16_bf16 v[80:95], v[76:79], v[252:255], v[80:95]
    s_mov_b32 exec_hi, 0
    s_nop 4
    ds_write_b32 v30, v40 offset:2048
    s_mov_b32 exec_hi, -1
    s_waitcnt lgkmcnt(0)
    s_waitcnt vmcnt(4)
    s_barrier
    s_cmp_lg_u32 s44, 7
    s_cbranch_scc1 L_nfh1
    s_mov_b32 s56, s51
    v_mov_b32 v16, s94
    v_mov_b32 v17, s95
    v_lshlrev_b32 v18, 0, v1
    s_mov_b64 exec, 0x1
    buffer_store_dwordx2 v[16:17], v18, s[16:19], s56 offen sc1
    s_mov_b64 exec, -1
L_nfh1:
    s_nop 3
    ds_read_b128 v[48:51], v31 offset:2048
    s_waitcnt lgkmcnt(0)
    v_add_f32 v48, v48, v49
    v_add_f32 v50, v50, v51
    v_add_f32 v48, v48, v50
    v_cvt_pk_bf16_f32 v52, v48, v48
    v_lshlrev_b32 v49, 16, v52
    v_sub_f32 v48, v48, v49
    v_lshlrev_b32 v49, 16, v29
    v_cvt_pk_bf16_f32 v53, v48, v49
    v_mov_b32 v54, v29
    v_mov_b32 v55, 0
    s_nop 1
    v_mfma_f32_32x32x16_bf16 v[80:95], v[52:55], v[32:35], v[80:95]
    s_nop 7
    s_nop 3
    v_mul_f32 v56, v80, v80
    v_fma_f32 v56, v56, v23, v22
    v_mul_f32 v57, v81, v81
    v_mul_f32 v56, v56, v80
    v_fma_f32 v57, v57, v23, v22
    v_mul_f32 v58, v82, v82
    v_exp_f32 v56, v56
    v_mul_f32 v57, v57, v81
    v_fma_f32 v58, v58, v23, v22
    v_mul_f32 v59, v83, v83
    v_fma_f32 v56, v56, v24, v24
    v_exp_f32 v57, v57
    v_mul_f32 v58, v58, v82
    v_fma_f32 v59, v59, v23, v22
    v_mul_f32 v60, v84, v84
    v_rcp_f32 v56, v56
    v_fma_f32 v57, v57, v24, v24
    v_exp_f32 v58, v58
    v_mul_f32 v59, v59, v83
    v_fma_f32 v60, v60, v23, v22
    v_mul_f32 v61, v85, v85
    v_mul_f32 v80, v56, v80
    v_rcp_f32 v57, v57
    v_fma_f32 v58, v58, v24, v24
    v_exp_f32 v59, v59
    v_mul_f32 v60, v60, v84
    v_fma_f32 v61, v61, v23, v22
    v_mul_f32 v62, v86, v86
    v_mul_f32 v81, v57, v81
    v_rcp_f32 v58, v58
    v_fma_f32 v59, v59, v24, v24
    v_exp_f32 v60, v60
    v_mul_f32 v61, v61, v85
    v_fma_f32 v62, v62, v23, v22
    v_mul_f32 v63, v87, v87
    v_cvt_pk_bf16_f32 v48, v80, v81
    v_mul_f32 v82, v58, v82
    v_rcp_f32 v59, v59
    v_fma_f32 v60, v60, v24, v24
    v_exp_f32 v61, v61
    v_mul_f32 v62, v62, v86
    v_fma_f32 v63, v63, v23, v22
    v_mul_f32 v56, v88, v88
    v_mul_f32 v83, v59, v83
    v_rcp_f32 v60, v60
    v_fma_f32 v61, v61, v24, v24
    v_exp_f32 v62, v62
    v_mul_f32 v63, v63, v87
    v_fma_f32 v56, v56, v23, v22
    v_mul_f32 v57, v89, v89
    v_cvt_pk_bf16_f32 v49, v82, v83
    v_mul_f32 v84, v60, v84
    v_rcp_f32 v61, v61
    v_fma_f32 v62, v62, v24, v24
    v_exp_f32 v63, v63
    v_mul_f32 v56, v56, v88
    v_fma_f32 v57, v57, v23, v22
    v_mul_f32 v58, v90, v90
    v_mul_f32 v85, v61, v85
    v_rcp_f32 v62, v62
    v_fma_f32 v63, v63, v24, v24
    v_exp_f32 v56, v56
    v_mul_f32 v57, v57, v89
    v_fma_f32 v58, v58, v23, v22
    v_mul_f32 v59, v91, v91
    v_cvt_pk_bf16_f32 v50, v84, v85
    v_mul_f32 v86, v62, v86
    v_rcp_f32 v63, v63
    v_fma_f32 v56, v56, v24, v24
    v_exp_f32 v57, v57
    v_mul_f32 v58, v58, v90
    v_fma_f32 v59, v59, v23, v22
    v_mul_f32 v60, v92, v92
    v_mul_f32 v87, v63, v87
    v_rcp_f32 v56, v56
    v_fma_f32 v57, v57, v24, v24
    v_exp_f32 v58, v58
    v_mul_f32 v59, v59, v91
    v_fma_f32 v60, v60, v23, v22
    v_mul_f32 v61, v93, v93
    v_cvt_pk_bf16_f32 v51, v86, v87
    s_add_u32 s58, s54, 8192
    buffer_store_dwordx4 v[48:51], v6, s[16:19], s58 offen sc1
    v_mul_f32 v88, v56, v88
    v_rcp_f32 v57, v57
    v_fma_f32 v58, v58, v24, v24
    v_exp_f32 v59, v59
    v_mul_f32 v60, v60, v92
    v_fma_f32 v61, v61, v23, v22
    v_mul_f32 v62, v94, v94
    v_mul_f32 v89, v57, v89
    v_rcp_f32 v58, v58
    v_fma_f32 v59, v59, v24, v24
    v_exp_f32 v60, v60
    v_mul_f32 v61, v61, v93
    v_fma_f32 v62, v62, v23, v22
    v_mul_f32 v63, v95, v95
    v_cvt_pk_bf16_f32 v52, v88, v89
    v_mul_f32 v90, v58, v90
    v_rcp_f32 v59, v59
    v_fma_f32 v60, v60, v24, v24
    v_exp_f32 v61, v61
    v_mul_f32 v62, v62, v94
    v_fma_f32 v63, v63, v23, v22
    v_mul_f32 v91, v59, v91
    v_rcp_f32 v60, v60
    v_fma_f32 v61, v61, v24, v24
    v_exp_f32 v62, v62
    v_mul_f32 v63, v63, v95
    v_cvt_pk_bf16_f32 v53, v90, v91
    v_mul_f32 v92, v60, v92
    v_rcp_f32 v61, v61
    v_fma_f32 v62, v62, v24, v24
    v_exp_f32 v63, v63
    v_mul_f32 v93, v61, v93
    v_rcp_f32 v62, v62
    v_fma_f32 v63, v63, v24, v24
    v_cvt_pk_bf16_f32 v54, v92, v93
    v_mul_f32 v94, v62, v94
    v_rcp_f32 v63, v63
    s_nop 0
    v_mul_f32 v95, v63, v95
    v_cvt_pk_bf16_f32 v55, v94, v95
    s_add_u32 s58, s54, 9216
    buffer_store_dwordx4 v[52:55], v6, s[16:19], s58 offen sc1
    v_and_b32 v5, 15, v1
    v_lshlrev_b32 v5, 3, v5
    s_cmp_lg_u32 s3, 0
    s_cbranch_scc1 L_nored0
    s_lshl_b32 s55, s47, 2
    s_add_u32 s55, s55, s45
    s_lshl_b32 s56, s48, 6
    s_add_u32 s55, s55, s56
    s_lshr_b32 s65, s55, 2
    s_lshl_b32 s65, s65, 7
    s_add_u32 s65, s65, 14811136
    buffer_load_dwordx2 v[14:15], v5, s[16:19], s65 offen sc1
L_nored0:
    s_nop 3
    s_waitcnt vmcnt(0)
    v_mov_b32 v20, 163328
    v_mov_b32 v21, 1
    s_mov_b64 exec, 1
    ds_add_rtn_u32 v21, v20, v21
    s_mov_b64 exec, -1
    s_waitcnt lgkmcnt(0)
    v_readfirstlane_b32 s56, v21
    s_nop 0
    s_cmp_lg_u32 s56, 7
    s_cbranch_scc1 L_nfh2H
    s_add_u32 s56, s51, 32768
    v_mov_b32 v20, s94
    v_mov_b32 v21, s95
    v_lshlrev_b32 v22, 0, v1
    s_mov_b64 exec, 0x1
    buffer_store_dwordx2 v[20:21], v22, s[16:19], s56 offen sc1
    s_mov_b64 exec, -1
L_nfh2H:
    s_nop 3
    s_cmp_lg_u32 s3, 0
    s_cbranch_scc1 L_nored1
    s_waitcnt vmcnt(0)
    s_mov_b32 s57, 8000
L_plr:
    v_cmp_ne_u64 vcc, s[94:95], v[14:15]
    s_nop 1
    s_cmp_eq_u64 vcc, 0
    s_cbranch_scc1 L_plrx
    s_sleep 4
    buffer_load_dwordx2 v[14:15], v5, s[16:19], s65 offen sc1
    s_waitcnt vmcnt(0)
    s_sub_u32 s57, s57, 1
    s_cmp_lg_u32 s57, 0
    s_cbranch_scc1 L_plr
L_plrx:
    s_lshl_b32 s56, s55, 13
    s_add_u32 s56, s56, 10485760
    s_add_u32 s57, s56, 4096
    buffer_load_dwordx4 v[192:195], v6, s[16:19], s56 offen offset:0 sc1
    buffer_load_dwordx4 v[196:199], v6, s[16:19], s56 offen offset:1024 sc1
    buffer_load_dwordx4 v[200:203], v6, s[16:19], s56 offen offset:2048 sc1
    buffer_load_dwordx4 v[204:207], v6, s[16:19], s56 offen offset:3072 sc1
    buffer_load_dwordx4 v[208:211], v6, s[16:19], s57 offen offset:0 sc1
    buffer_load_dwordx4 v[212:215], v6, s[16:19], s57 offen offset:1024 sc1
    buffer_load_dwordx4 v[216:219], v6, s[16:19], s57 offen offset:2048 sc1
    buffer_load_dwordx4 v[220:223], v6, s[16:19], s57 offen offset:3072 sc1
L_nored1:
    s_nop 3
    s_add_u32 m0, s50, 81920
    s_mul_i32 s56, s44, 196608
    s_add_u32 s56, s56, s62
    s_add_u32 s56, s56, 81920
    buffer_load_dwordx4 v7, s[20:23], s56 offen lds
    buffer_load_dwordx4 v0, s[20:23], s56 offen offset:1024 lds
    s_add_u32 m0, s50, 98304
    s_mul_i32 s56, s44, 196608
    s_add_u32 s56, s56, s62
    s_add_u32 s56, s56, 98304
    buffer_load_dwordx4 v7, s[20:23], s56 offen lds
    buffer_load_dwordx4 v0, s[20:23], s56 offen offset:1024 lds
    s_add_u32 m0, s50, 114688
    s_mul_i32 s56, s44, 196608
    s_add_u32 s56, s56, s62
    s_add_u32 s56, s56, 114688
    buffer_load_dwordx4 v7, s[20:23], s56 offen lds
    buffer_load_dwordx4 v0, s[20:23], s56 offen offset:1024 lds
    s_add_u32 m0, s50, 131072
    s_mul_i32 s56, s44, 196608
    s_add_u32 s56, s56, s62
    s_add_u32 s56, s56, 131072
    buffer_load_dwordx4 v7, s[20:23], s56 offen lds
    buffer_load_dwordx4 v0, s[20:23], s56 offen offset:1024 lds
    v_mov_b32 v4, 0
    s_lshr_b32 s53, s59, 1
    s_lshl_b32 s53, s53, 4
    s_add_u32 s53, s53, s44
    s_lshl_b32 s53, s53, 7
    s_add_u32 s64, s53, 14746624
    s_add_u32 s53, s53, 14778368
    s_add_u32 s52, s53, 1024
    buffer_load_dwordx2 v[2:3], v4, s[16:19], s64 offen sc1
    s_cmp_lg_u32 s3, 0
    s_cbranch_scc1 L_nored2
    s_lshr_b32 s57, s47, 1
    s_xor_b32 s57, s57, s45
    s_bitcmp0_b32 s57, 1
    s_cselect_b32 s57, 0x3f317218, 1.0
    s_and_b32 s56, s55, 0x1f0
    s_lshl_b32 s56, s56, 6
    s_and_b32 s58, s55, 7
    s_lshl_b32 s58, s58, 7
    s_add_u32 s56, s56, s58
    s_and_b32 s58, s55, 8
    s_add_u32 s56, s56, s58
    s_add_u32 s56, s56, 14680064
    s_waitcnt vmcnt(9)
    v_add_f32 v192, v192, v196
    v_add_f32 v193, v193, v197
    v_add_f32 v194, v194, v198
    v_add_f32 v195, v195, v199
    v_add_f32 v192, v192, v200
    v_add_f32 v193, v193, v201
    v_add_f32 v194, v194, v202
    v_add_f32 v195, v195, v203
    v_add_f32 v192, v192, v204
    v_add_f32 v193, v193, v205
    v_add_f32 v194, v194, v206
    v_add_f32 v195, v195, v207
    v_add_f32 v192, v192, v208
    v_add_f32 v193, v193, v209
    v_add_f32 v194, v194, v210
    v_add_f32 v195, v195, v211
    v_add_f32 v192, v192, v212
    v_add_f32 v193, v193, v213
    v_add_f32 v194, v194, v214
    v_add_f32 v195, v195, v215
    v_add_f32 v192, v192, v216
    v_add_f32 v193, v193, v217
    v_add_f32 v194, v194, v218
    v_add_f32 v195, v195, v219
    v_add_f32 v192, v192, v220
    v_add_f32 v193, v193, v221
    v_add_f32 v194, v194, v222
    v_add_f32 v195, v195, v223
    v_add_f32_dpp v192, v192, v192 row_ror:8 row_mask:0xf bank_mask:0xf
    v_add_f32_dpp v193, v193, v193 row_ror:8 row_mask:0xf bank_mask:0xf
    v_add_f32_dpp v194, v194, v194 row_ror:8 row_mask:0xf bank_mask:0xf
    v_add_f32_dpp v195, v195, v195 row_ror:8 row_mask:0xf bank_mask:0xf
    v_mov_b32 v196, v192
    v_mov_b32 v197, v193
    v_mov_b32 v198, v194
    v_mov_b32 v199, v195
    v_permlane16_swap_b32 v196, v192
    v_permlane16_swap_b32 v197, v193
    v_permlane16_swap_b32 v198, v194
    v_permlane16_swap_b32 v199, v195
    v_add_f32 v192, v192, v196
    v_add_f32 v193, v193, v197
    v_add_f32 v194, v194, v198
    v_add_f32 v195, v195, v199
    v_mov_b32 v196, v192
    v_mov_b32 v197, v193
    v_mov_b32 v198, v194
    v_mov_b32 v199, v195
    v_permlane32_swap_b32 v196, v192
    v_permlane32_swap_b32 v197, v193
    v_permlane32_swap_b32 v198, v194
    v_permlane32_swap_b32 v199, v195
    v_add_f32 v192, v192, v196
    v_add_f32 v193, v193, v197
    v_add_f32 v194, v194, v198
    v_add_f32 v195, v195, v199
    v_mul_f32 v192, s57, v192
    v_mul_f32 v193, s57, v193
    v_mul_f32 v194, s57, v194
    v_mul_f32 v195, s57, v195
    v_cvt_pk_bf16_f32 v192, v192, v193
    v_cvt_pk_bf16_f32 v193, v194, v195
    s_mov_b64 exec, 0xff
    buffer_store_dwordx2 v[192:193], v6, s[16:19], s56 offen sc1
    s_mov_b64 exec, -1
L_nored2:
    s_nop 3
    s_setprio 3
L_p2:
    s_nop 7
    s_nop 4
    v_and_b32 v5, 15, v1
    v_lshlrev_b32 v5, 3, v5
    s_lshr_b32 s54, s59, 2
    s_lshl_b32 s54, s54, 3
    s_add_u32 s54, s54, s44
    s_lshl_b32 s54, s54, 7
    s_add_u32 s54, s54, 14843904
    v_add_u32 v8, 147456, v6
    s_mul_i32 s61, s59, 294912
    s_waitcnt vmcnt(0)
    s_mov_b32 s57, 8000
L_plh1:
    v_cmp_ne_u64 vcc, s[94:95], v[2:3]
    s_nop 1
    s_cmp_eq_u64 vcc, 0
    s_cbranch_scc1 L_plh1x
    s_sleep 4
    buffer_load_dwordx2 v[2:3], v4, s[16:19], s64 offen sc1
    s_waitcnt vmcnt(0)
    s_sub_u32 s57, s57, 1
    s_cmp_lg_u32 s57, 0
    s_cbranch_scc1 L_plh1
L_plh1x:
    s_mul_i32 s56, s44, 12288
    s_add_u32 s56, s56, s61
    s_add_u32 s56, s56, 0
    buffer_load_dwordx4 v[40:43], v6, s[16:19], s56 offen sc1
    buffer_load_dwordx4 v[44:47], v8, s[16:19], s56 offen sc1
    s_mul_i32 s56, s44, 12288
    s_add_u32 s56, s56, s61
    s_add_u32 s56, s56, 1024
    buffer_load_dwordx4 v[48:51], v6, s[16:19], s56 offen sc1
    buffer_load_dwordx4 v[52:55], v8, s[16:19], s56 offen sc1
    s_mul_i32 s56, s44, 12288
    s_add_u32 s56, s56, s61
    s_add_u32 s56, s56, 2048
    buffer_load_dwordx4 v[56:59], v6, s[16:19], s56 offen sc1
    buffer_load_dwordx4 v[60:63], v8, s[16:19], s56 offen sc1
    s_mul_i32 s56, s44, 12288
    s_add_u32 s56, s56, s61
    s_add_u32 s56, s56, 3072
    buffer_load_dwordx4 v[64:67], v6, s[16:19], s56 offen sc1
    buffer_load_dwordx4 v[68:71], v8, s[16:19], s56 offen sc1
    buffer_load_dwordx2 v[12:13], v4, s[16:19], s52 offen sc1
    ds_read_b64_tr_b16 v[168:169], v9 offset:16384
    ds_read_b64_tr_b16 v[170:171], v9 offset:17408
    ds_read_b64_tr_b16 v[172:173], v10 offset:16384
    ds_read_b64_tr_b16 v[174:175], v10 offset:17408
    ds_read_b64_tr_b16 v[176:177], v9 offset:32768
    ds_read_b64_tr_b16 v[178:179], v9 offset:33792
    ds_read_b64_tr_b16 v[180:181], v10 offset:32768
    ds_read_b64_tr_b16 v[182:183], v10 offset:33792
    ds_read_b64_tr_b16 v[184:185], v9 offset:49152
    ds_read_b64_tr_b16 v[186:187], v9 offset:50176
    ds_read_b64_tr_b16 v[188:189], v10 offset:49152
    ds_read_b64_tr_b16 v[190:191], v10 offset:50176
    v_add_u32 v9, 0x10000, v9
    ds_read_b64_tr_b16 v[120:121], v9 offset:0
    ds_read_b64_tr_b16 v[122:123], v9 offset:1024
    v_add_u32 v10, 0x10000, v10
    ds_read_b64_tr_b16 v[124:125], v10 offset:0
    ds_read_b64_tr_b16 v[126:127], v10 offset:1024
    s_cmp_lg_u32 s3, 0
    s_cbranch_scc1 L_nored3
    s_waitcnt vmcnt(9)
    v_mov_b32 v16, 163332
    v_mov_b32 v17, 1
    s_mov_b64 exec, 1
    ds_add_rtn_u32 v17, v16, v17
    s_mov_b64 exec, -1
    s_waitcnt lgkmcnt(0)
    v_readfirstlane_b32 s56, v17
    s_nop 0
    s_cmp_lg_u32 s56, 3
    s_cbranch_scc1 L_nfr
    s_lshr_b32 s56, s55, 2
    s_lshl_b32 s56, s56, 3
    s_add_u32 s56, s56, 14843904
    v_mov_b32 v16, s94
    v_mov_b32 v17, s95
    v_lshlrev_b32 v18, 10, v1
    s_mov_b64 exec, 0xff
    buffer_store_dwordx2 v[16:17], v18, s[16:19], s56 offen sc1
    s_mov_b64 exec, -1
L_nfr:
    s_nop 3
L_nored3:
    s_nop 3
    s_setprio 0
    s_mul_i32 s56, s44, 12288
    s_add_u32 s56, s56, s61
    s_add_u32 s56, s56, 4096
    buffer_load_dwordx4 v[72:75], v6, s[16:19], s56 offen sc1
    buffer_load_dwordx4 v[76:79], v8, s[16:19], s56 offen sc1
    s_mul_i32 s56, s44, 12288
    s_add_u32 s56, s56, s61
    s_add_u32 s56, s56, 5120
    buffer_load_dwordx4 v[80:83], v6, s[16:19], s56 offen sc1
    buffer_load_dwordx4 v[84:87], v8, s[16:19], s56 offen sc1
    s_mul_i32 s56, s44, 12288
    s_add_u32 s56, s56, s61
    s_add_u32 s56, s56, 6144
    buffer_load_dwordx4 v[88:91], v6, s[16:19], s56 offen sc1
    buffer_load_dwordx4 v[92:95], v8, s[16:19], s56 offen sc1
    s_mul_i32 s56, s44, 12288
    s_add_u32 s56, s56, s61
    s_add_u32 s56, s56, 7168
    buffer_load_dwordx4 v[96:99], v6, s[16:19], s56 offen sc1
    buffer_load_dwordx4 v[100:103], v8, s[16:19], s56 offen sc1
    s_waitcnt lgkmcnt(0)
    s_waitcnt vmcnt(15)
    v_mfma_f32_32x32x16_bf16 v[192:207], v[128:131], v[40:43], 0
    v_mfma_f32_32x32x16_bf16 v[208:223], v[128:131], v[44:47], 0
    v_mfma_f32_32x32x16_bf16 v[224:239], v[132:135], v[40:43], 0
    v_mfma_f32_32x32x16_bf16 v[240:255], v[132:135], v[44:47], 0
    s_waitcnt vmcnt(8)
    s_mov_b32 s57, 8000
L_plh2:
    v_cmp_ne_u64 vcc, s[94:95], v[12:13]
    s_nop 1
    s_cmp_eq_u64 vcc, 0
    s_cbranch_scc1 L_plh2x
    s_sleep 4
    buffer_load_dwordx2 v[12:13], v4, s[16:19], s52 offen sc1
    s_waitcnt vmcnt(0)
    s_sub_u32 s57, s57, 1
    s_cmp_lg_u32 s57, 0
    s_cbranch_scc1 L_plh2
L_plh2x:
    s_mul_i32 s56, s44, 12288
    s_add_u32 s56, s56, s61
    s_add_u32 s56, s56, 8192
    buffer_load_dwordx4 v[40:43], v6, s[16:19], s56 offen sc1
    buffer_load_dwordx4 v[44:47], v8, s[16:19], s56 offen sc1
    buffer_load_dwordx2 v[2:3], v4, s[16:19], s53 offen sc1
    s_add_u32 m0, s50, 81920
    s_mul_i32 s56, s44, 65536
    s_add_u32 s56, s56, s62
    s_add_u32 s56, s56, 0
    buffer_load_dwordx4 v7, s[24:27], s56 offen lds
    buffer_load_dwordx4 v0, s[24:27], s56 offen offset:1024 lds
    v_mfma_f32_32x32x16_bf16 v[192:207], v[136:139], v[48:51], v[192:207]
    v_mfma_f32_32x32x16_bf16 v[208:223], v[136:139], v[52:55], v[208:223]
    v_mfma_f32_32x32x16_bf16 v[224:239], v[140:143], v[48:51], v[224:239]
    v_mfma_f32_32x32x16_bf16 v[240:255], v[140:143], v[52:55], v[240:255]
    s_mul_i32 s56, s44, 12288
    s_add_u32 s56, s56, s61
    s_add_u32 s56, s56, 9216
    buffer_load_dwordx4 v[48:51], v6, s[16:19], s56 offen sc1
    buffer_load_dwordx4 v[52:55], v8, s[16:19], s56 offen sc1
    s_add_u32 m0, s50, 98304
    s_mul_i32 s56, s44, 65536
    s_add_u32 s56, s56, s62
    s_add_u32 s56, s56, 16384
    buffer_load_dwordx4 v7, s[24:27], s56 offen lds
    buffer_load_dwordx4 v0, s[24:27], s56 offen offset:1024 lds
    v_mfma_f32_32x32x16_bf16 v[192:207], v[144:147], v[56:59], v[192:207]
    v_mfma_f32_32x32x16_bf16 v[208:223], v[144:147], v[60:63], v[208:223]
    v_mfma_f32_32x32x16_bf16 v[224:239], v[148:151], v[56:59], v[224:239]
    v_mfma_f32_32x32x16_bf16 v[240:255], v[148:151], v[60:63], v[240:255]
    s_mul_i32 s56, s44, 12288
    s_add_u32 s56, s56, s61
    s_add_u32 s56, s56, 10240
    buffer_load_dwordx4 v[56:59], v6, s[16:19], s56 offen sc1
    buffer_load_dwordx4 v[60:63], v8, s[16:19], s56 offen sc1
    v_mfma_f32_32x32x16_bf16 v[192:207], v[152:155], v[64:67], v[192:207]
    v_mfma_f32_32x32x16_bf16 v[208:223], v[152:155], v[68:71], v[208:223]
    v_mfma_f32_32x32x16_bf16 v[224:239], v[156:159], v[64:67], v[224:239]
    v_mfma_f32_32x32x16_bf16 v[240:255], v[156:159], v[68:71], v[240:255]
    s_mul_i32 s56, s44, 12288
    s_add_u32 s56, s56, s61
    s_add_u32 s56, s56, 11264
    buffer_load_dwordx4 v[64:67], v6, s[16:19], s56 offen sc1
    buffer_load_dwordx4 v[68:71], v8, s[16:19], s56 offen sc1
    s_add_u32 m0, s50, 114688
    s_mul_i32 s56, s44, 65536
    s_add_u32 s56, s56, s62
    s_add_u32 s56, s56, 32768
    buffer_load_dwordx4 v7, s[24:27], s56 offen lds
    buffer_load_dwordx4 v0, s[24:27], s56 offen offset:1024 lds
    s_waitcnt vmcnt(21)
    v_mfma_f32_32x32x16_bf16 v[192:207], v[160:163], v[72:75], v[192:207]
    v_mfma_f32_32x32x16_bf16 v[208:223], v[160:163], v[76:79], v[208:223]
    v_mfma_f32_32x32x16_bf16 v[224:239], v[164:167], v[72:75], v[224:239]
    v_mfma_f32_32x32x16_bf16 v[240:255], v[164:167], v[76:79], v[240:255]
    s_waitcnt vmcnt(12)
    s_mov_b32 s57, 8000
L_pla:
    v_cmp_ne_u64 vcc, s[94:95], v[2:3]
    s_nop 1
    s_cmp_eq_u64 vcc, 0
    s_cbranch_scc1 L_plax
    s_sleep 4
    buffer_load_dwordx2 v[2:3], v4, s[16:19], s53 offen sc1
    s_waitcnt vmcnt(0)
    s_sub_u32 s57, s57, 1
    s_cmp_lg_u32 s57, 0
    s_cbranch_scc1 L_pla
L_plax:
    s_mul_i32 s56, s44, 2048
    s_add_u32 s56, s56, s61
    s_add_u32 s56, s56, 98304
    buffer_load_dwordx4 v[72:75], v6, s[16:19], s56 offen sc1
    buffer_load_dwordx4 v[76:79], v8, s[16:19], s56 offen sc1
    v_mfma_f32_32x32x16_bf16 v[192:207], v[168:171], v[80:83], v[192:207]
    v_mfma_f32_32x32x16_bf16 v[208:223], v[168:171], v[84:87], v[208:223]
    v_mfma_f32_32x32x16_bf16 v[224:239], v[172:175], v[80:83], v[224:239]
    v_mfma_f32_32x32x16_bf16 v[240:255], v[172:175], v[84:87], v[240:255]
    s_mul_i32 s56, s44, 2048
    s_add_u32 s56, s56, s61
    s_add_u32 s56, s56, 99328
    buffer_load_dwordx4 v[80:83], v6, s[16:19], s56 offen sc1
    buffer_load_dwordx4 v[84:87], v8, s[16:19], s56 offen sc1
    s_add_u32 m0, s50, 131072
    s_mul_i32 s56, s44, 65536
    s_add_u32 s56, s56, s62
    s_add_u32 s56, s56, 49152
    buffer_load_dwordx4 v7, s[24:27], s56 offen lds
    buffer_load_dwordx4 v0, s[24:27], s56 offen offset:1024 lds
    v_mfma_f32_32x32x16_bf16 v[192:207], v[176:179], v[88:91], v[192:207]
    v_mfma_f32_32x32x16_bf16 v[208:223], v[176:179], v[92:95], v[208:223]
    v_mfma_f32_32x32x16_bf16 v[224:239], v[180:183], v[88:91], v[224:239]
    v_mfma_f32_32x32x16_bf16 v[240:255], v[180:183], v[92:95], v[240:255]
    s_mul_i32 s56, s44, 4096
    s_add_u32 s56, s56, s61
    s_add_u32 s56, s56, 114688
    buffer_load_dwordx4 v[88:91], v6, s[16:19], s56 offen sc1
    buffer_load_dwordx4 v[92:95], v8, s[16:19], s56 offen sc1
    v_mfma_f32_32x32x16_bf16 v[192:207], v[184:187], v[96:99], v[192:207]
    v_mfma_f32_32x32x16_bf16 v[208:223], v[184:187], v[100:103], v[208:223]
    v_mfma_f32_32x32x16_bf16 v[224:239], v[188:191], v[96:99], v[224:239]
    v_mfma_f32_32x32x16_bf16 v[240:255], v[188:191], v[100:103], v[240:255]
    s_mul_i32 s56, s44, 4096
    s_add_u32 s56, s56, s61
    s_add_u32 s56, s56, 115712
    buffer_load_dwordx4 v[96:99], v6, s[16:19], s56 offen sc1
    buffer_load_dwordx4 v[100:103], v8, s[16:19], s56 offen sc1
    v_add_u32 v9, 0xfffe0000, v9
    ds_read_b64_tr_b16 v[112:113], v9 offset:0
    ds_read_b64_tr_b16 v[114:115], v9 offset:1024
    v_add_u32 v10, 0xfffe0000, v10
    ds_read_b64_tr_b16 v[116:117], v10 offset:0
    ds_read_b64_tr_b16 v[118:119], v10 offset:1024
    v_mfma_f32_32x32x16_bf16 v[192:207], v[120:123], v[40:43], v[192:207]
    v_mfma_f32_32x32x16_bf16 v[208:223], v[120:123], v[44:47], v[208:223]
    v_mfma_f32_32x32x16_bf16 v[224:239], v[124:127], v[40:43], v[224:239]
    v_mfma_f32_32x32x16_bf16 v[240:255], v[124:127], v[44:47], v[240:255]
    s_mul_i32 s56, s44, 4096
    s_add_u32 s56, s56, s61
    s_add_u32 s56, s56, 116736
    buffer_load_dwordx4 v[40:43], v6, s[16:19], s56 offen sc1
    buffer_load_dwordx4 v[44:47], v8, s[16:19], s56 offen sc1
    buffer_load_dwordx2 v[12:13], v5, s[16:19], s54 offen sc1
    ds_read_b64_tr_b16 v[104:105], v9 offset:16384
    ds_read_b64_tr_b16 v[106:107], v9 offset:17408
    ds_read_b64_tr_b16 v[108:109], v10 offset:16384
    ds_read_b64_tr_b16 v[110:111], v10 offset:17408
    s_waitcnt vmcnt(21)
    s_waitcnt lgkmcnt(4)
    v_mfma_f32_32x32x16_bf16 v[192:207], v[112:115], v[48:51], v[192:207]
    v_mfma_f32_32x32x16_bf16 v[208:223], v[112:115], v[52:55], v[208:223]
    v_mfma_f32_32x32x16_bf16 v[224:239], v[116:119], v[48:51], v[224:239]
    v_mfma_f32_32x32x16_bf16 v[240:255], v[116:119], v[52:55], v[240:255]
    s_mul_i32 s56, s44, 4096
    s_add_u32 s56, s56, s61
    s_add_u32 s56, s56, 117760
    buffer_load_dwordx4 v[48:51], v6, s[16:19], s56 offen sc1
    buffer_load_dwordx4 v[52:55], v8, s[16:19], s56 offen sc1
    ds_read_b64_tr_b16 v[112:113], v9 offset:32768
    ds_read_b64_tr_b16 v[114:115], v9 offset:33792
    ds_read_b64_tr_b16 v[116:117], v10 offset:32768
    ds_read_b64_tr_b16 v[118:119], v10 offset:33792
    s_waitcnt vmcnt(2)
    s_mov_b32 s57, 8000
L_plk:
    v_cmp_ne_u64 vcc, s[94:95], v[12:13]
    s_nop 1
    s_cmp_eq_u64 vcc, 0
    s_cbranch_scc1 L_plkx
    s_sleep 4
    buffer_load_dwordx2 v[12:13], v5, s[16:19], s54 offen sc1
    s_waitcnt vmcnt(0)
    s_sub_u32 s57, s57, 1
    s_cmp_lg_u32 s57, 0
    s_cbranch_scc1 L_plk
L_plkx:
    s_lshl_b32 s56, s44, 12
    s_add_u32 s56, s56, 14680064
    buffer_load_dwordx4 v[24:27], v6, s[16:19], s56 offen offset:0 sc1
    buffer_load_dwordx4 v[28:31], v6, s[16:19], s56 offen offset:1024 sc1
    buffer_load_dwordx4 v[32:35], v6, s[16:19], s56 offen offset:2048 sc1
    buffer_load_dwordx4 v[36:39], v6, s[16:19], s56 offen offset:3072 sc1
    v_lshrrev_b32 v20, 3, v1
    v_lshlrev_b32 v11, 10, v20
    v_and_b32 v20, 7, v1
    v_lshlrev_b32 v20, 4, v20
    v_add_u32 v11, v11, v20
    s_lshl_b32 s58, s59, 16
    s_lshl_b32 s57, s44, 13
    s_add_u32 s58, s58, s57
    s_add_u32 s58, s58, s62
    buffer_load_dwordx4 v[12:15], v11, s[4:7], s58 offen
    buffer_load_dwordx4 v[16:19], v20, s[36:39], s62 offen
    s_waitcnt lgkmcnt(4)
    v_mfma_f32_32x32x16_bf16 v[192:207], v[104:107], v[56:59], v[192:207]
    v_mfma_f32_32x32x16_bf16 v[208:223], v[104:107], v[60:63], v[208:223]
    v_mfma_f32_32x32x16_bf16 v[224:239], v[108:111], v[56:59], v[224:239]
    v_mfma_f32_32x32x16_bf16 v[240:255], v[108:111], v[60:63], v[240:255]
    ds_read_b64_tr_b16 v[104:105], v9 offset:49152
    ds_read_b64_tr_b16 v[106:107], v9 offset:50176
    ds_read_b64_tr_b16 v[108:109], v10 offset:49152
    ds_read_b64_tr_b16 v[110:111], v10 offset:50176
    s_waitcnt lgkmcnt(4)
    v_mfma_f32_32x32x16_bf16 v[192:207], v[112:115], v[64:67], v[192:207]
    v_mfma_f32_32x32x16_bf16 v[208:223], v[112:115], v[68:71], v[208:223]
    v_mfma_f32_32x32x16_bf16 v[224:239], v[116:119], v[64:67], v[224:239]
    v_mfma_f32_32x32x16_bf16 v[240:255], v[116:119], v[68:71], v[240:255]
    v_add_u32 v9, 0x10000, v9
    ds_read_b64_tr_b16 v[112:113], v9 offset:0
    ds_read_b64_tr_b16 v[114:115], v9 offset:1024
    v_add_u32 v10, 0x10000, v10
    ds_read_b64_tr_b16 v[116:117], v10 offset:0
    ds_read_b64_tr_b16 v[118:119], v10 offset:1024
    s_waitcnt lgkmcnt(4)
    v_mfma_f32_32x32x16_bf16 v[192:207], v[104:107], v[72:75], v[192:207]
    v_and_b32 v20, 15, v1
    v_lshrrev_b32 v21, 5, v1
    v_xor_b32 v20, v20, v21
    v_lshlrev_b32 v22, 4, v20
    v_mfma_f32_32x32x16_bf16 v[208:223], v[104:107], v[76:79], v[208:223]
    v_and_b32 v20, 7, v1
    v_lshl_add_u32 v22, v20, 8, v22
    v_bfe_u32 v20, v1, 3, 2
    v_lshl_add_u32 v22, v20, 14, v22
    v_add_u32 v22, s50, v22
    v_mfma_f32_32x32x16_bf16 v[224:239], v[108:111], v[72:75], v[224:239]
    v_lshrrev_b32 v20, 3, v1
    v_and_b32 v21, 7, v1
    v_lshlrev_b32 v21, 1, v21
    v_xor_b32 v21, v21, v20
    s_and_b32 s56, s44, 1
    s_lshl_b32 s56, s56, 3
    v_xor_b32 v21, s56, v21
    v_lshlrev_b32 v21, 4, v21
    v_mfma_f32_32x32x16_bf16 v[240:255], v[108:111], v[76:79], v[240:255]
    v_lshl_add_u32 v21, v20, 8, v21
    s_lshl_b32 s56, s44, 14
    v_add_u32 v21, s56, v21
    v_xor_b32 v20, 16, v21
    ds_read_b64_tr_b16 v[104:105], v9 offset:16384
    ds_read_b64_tr_b16 v[106:107], v9 offset:17408
    ds_read_b64_tr_b16 v[108:109], v10 offset:16384
    ds_read_b64_tr_b16 v[110:111], v10 offset:17408
    s_waitcnt vmcnt(2)
    v_mfma_f32_32x32x16_bf16 v[120:135], v[24:27], v[88:91], 0
    v_mfma_f32_32x32x16_bf16 v[136:151], v[24:27], v[92:95], 0
    s_waitcnt lgkmcnt(4)
    v_mfma_f32_32x32x16_bf16 v[192:207], v[112:115], v[80:83], v[192:207]
    s_nop 7
    s_nop 0
    v_add_f32 v128, 0x358637bd, v128
    v_rcp_f32 v128, v128
    s_nop 0
    v_mul_f32 v120, v120, v128
    v_mul_f32 v121, v121, v128
    v_mul_f32 v122, v122, v128
    v_mul_f32 v123, v123, v128
    v_mul_f32 v124, v124, v128
    v_mul_f32 v125, v125, v128
    v_mfma_f32_32x32x16_bf16 v[208:223], v[112:115], v[84:87], v[208:223]
    v_mul_f32 v126, v126, v128
    v_mul_f32 v127, v127, v128
    v_cvt_pk_bf16_f32 v88, v120, v121
    v_cvt_pk_bf16_f32 v89, v122, v123
    v_cvt_pk_bf16_f32 v90, v124, v125
    v_cvt_pk_bf16_f32 v91, v126, v127
    v_mfma_f32_32x32x16_bf16 v[224:239], v[116:119], v[80:83], v[224:239]
    v_add_f32 v144, 0x358637bd, v144
    v_rcp_f32 v144, v144
    s_nop 0
    v_mul_f32 v136, v136, v144
    v_mul_f32 v137, v137, v144
    v_mul_f32 v138, v138, v144
    v_mul_f32 v139, v139, v144
    v_mul_f32 v140, v140, v144
    v_mul_f32 v141, v141, v144
    v_mfma_f32_32x32x16_bf16 v[240:255], v[116:119], v[84:87], v[240:255]
    v_mul_f32 v142, v142, v144
    v_mul_f32 v143, v143, v144
    v_cvt_pk_bf16_f32 v92, v136, v137
    v_cvt_pk_bf16_f32 v93, v138, v139
    v_cvt_pk_bf16_f32 v94, v140, v141
    v_cvt_pk_bf16_f32 v95, v142, v143
    ds_read_b64_tr_b16 v[112:113], v9 offset:32768
    ds_read_b64_tr_b16 v[114:115], v9 offset:33792
    ds_read_b64_tr_b16 v[116:117], v10 offset:32768
    ds_read_b64_tr_b16 v[118:119], v10 offset:33792
    v_mfma_f32_32x32x16_bf16 v[120:135], v[28:31], v[96:99], 0
    v_mfma_f32_32x32x16_bf16 v[136:151], v[28:31], v[100:103], 0
    s_waitcnt lgkmcnt(4)
    v_mfma_f32_32x32x16_bf16 v[192:207], v[104:107], v[88:91], v[192:207]
    s_nop 7
    s_nop 0
    v_add_f32 v120, 0x358637bd, v120
    v_rcp_f32 v120, v120
    s_nop 0
    v_mul_f32 v128, v128, v120
    v_mul_f32 v129, v129, v120
    v_mul_f32 v130, v130, v120
    v_mul_f32 v131, v131, v120
    v_mul_f32 v132, v132, v120
    v_mul_f32 v133, v133, v120
    v_mfma_f32_32x32x16_bf16 v[208:223], v[104:107], v[92:95], v[208:223]
    v_mul_f32 v134, v134, v120
    v_mul_f32 v135, v135, v120
    v_cvt_pk_bf16_f32 v96, v128, v129
    v_cvt_pk_bf16_f32 v97, v130, v131
    v_cvt_pk_bf16_f32 v98, v132, v133
    v_cvt_pk_bf16_f32 v99, v134, v135
    v_mfma_f32_32x32x16_bf16 v[224:239], v[108:111], v[88:91], v[224:239]
    v_add_f32 v136, 0x358637bd, v136
    v_rcp_f32 v136, v136
    s_nop 0
    v_mul_f32 v144, v144, v136
    v_mul_f32 v145, v145, v136
    v_mul_f32 v146, v146, v136
    v_mul_f32 v147, v147, v136
    v_mul_f32 v148, v148, v136
    v_mul_f32 v149, v149, v136
    v_mfma_f32_32x32x16_bf16 v[240:255], v[108:111], v[92:95], v[240:255]
    v_mul_f32 v150, v150, v136
    v_mul_f32 v151, v151, v136
    v_cvt_pk_bf16_f32 v100, v144, v145
    v_cvt_pk_bf16_f32 v101, v146, v147
    v_cvt_pk_bf16_f32 v102, v148, v149
    v_cvt_pk_bf16_f32 v103, v150, v151
    ds_read_b64_tr_b16 v[104:105], v9 offset:49152
    ds_read_b64_tr_b16 v[106:107], v9 offset:50176
    ds_read_b64_tr_b16 v[108:109], v10 offset:49152
    ds_read_b64_tr_b16 v[110:111], v10 offset:50176
    v_mfma_f32_32x32x16_bf16 v[120:135], v[32:35], v[40:43], 0
    v_mfma_f32_32x32x16_bf16 v[136:151], v[32:35], v[44:47], 0
    s_waitcnt lgkmcnt(4)
    v_mfma_f32_32x32x16_bf16 v[192:207], v[112:115], v[96:99], v[192:207]
    s_nop 7
    s_nop 0
    v_add_f32 v128, 0x358637bd, v128
    v_rcp_f32 v128, v128
    s_nop 0
    v_mul_f32 v120, v120, v128
    v_mul_f32 v121, v121, v128
    v_mul_f32 v122, v122, v128
    v_mul_f32 v123, v123, v128
    v_mul_f32 v124, v124, v128
    v_mul_f32 v125, v125, v128
    v_mfma_f32_32x32x16_bf16 v[208:223], v[112:115], v[100:103], v[208:223]
    v_mul_f32 v126, v126, v128
    v_mul_f32 v127, v127, v128
    v_cvt_pk_bf16_f32 v40, v120, v121
    v_cvt_pk_bf16_f32 v41, v122, v123
    v_cvt_pk_bf16_f32 v42, v124, v125
    v_cvt_pk_bf16_f32 v43, v126, v127
    v_mfma_f32_32x32x16_bf16 v[224:239], v[116:119], v[96:99], v[224:239]
    v_add_f32 v144, 0x358637bd, v144
    v_rcp_f32 v144, v144
    s_nop 0
    v_mul_f32 v136, v136, v144
    v_mul_f32 v137, v137, v144
    v_mul_f32 v138, v138, v144
    v_mul_f32 v139, v139, v144
    v_mul_f32 v140, v140, v144
    v_mul_f32 v141, v141, v144
    v_mfma_f32_32x32x16_bf16 v[240:255], v[116:119], v[100:103], v[240:255]
    v_mul_f32 v142, v142, v144
    v_mul_f32 v143, v143, v144
    v_cvt_pk_bf16_f32 v44, v136, v137
    v_cvt_pk_bf16_f32 v45, v138, v139
    v_cvt_pk_bf16_f32 v46, v140, v141
    v_cvt_pk_bf16_f32 v47, v142, v143
    v_add_u32 v9, 0x10000, v9
    ds_read_b64_tr_b16 v[112:113], v9 offset:0
    ds_read_b64_tr_b16 v[114:115], v9 offset:1024
    v_add_u32 v10, 0x10000, v10
    ds_read_b64_tr_b16 v[116:117], v10 offset:0
    ds_read_b64_tr_b16 v[118:119], v10 offset:1024
    v_mfma_f32_32x32x16_bf16 v[120:135], v[36:39], v[48:51], 0
    v_mfma_f32_32x32x16_bf16 v[136:151], v[36:39], v[52:55], 0
    s_waitcnt lgkmcnt(4)
    v_mfma_f32_32x32x16_bf16 v[192:207], v[104:107], v[40:43], v[192:207]
    s_nop 7
    s_nop 0
    v_add_f32 v120, 0x358637bd, v120
    v_rcp_f32 v120, v120
    s_nop 0
    v_mul_f32 v128, v128, v120
    v_mul_f32 v129, v129, v120
    v_mul_f32 v130, v130, v120
    v_mul_f32 v131, v131, v120
    v_mul_f32 v132, v132, v120
    v_mul_f32 v133, v133, v120
    v_mfma_f32_32x32x16_bf16 v[208:223], v[104:107], v[44:47], v[208:223]
    v_mul_f32 v134, v134, v120
    v_mul_f32 v135, v135, v120
    v_cvt_pk_bf16_f32 v48, v128, v129
    v_cvt_pk_bf16_f32 v49, v130, v131
    v_cvt_pk_bf16_f32 v50, v132, v133
    v_cvt_pk_bf16_f32 v51, v134, v135
    v_mfma_f32_32x32x16_bf16 v[224:239], v[108:111], v[40:43], v[224:239]
    v_add_f32 v136, 0x358637bd, v136
    v_rcp_f32 v136, v136
    s_nop 0
    v_mul_f32 v144, v144, v136
    v_mul_f32 v145, v145, v136
    v_mul_f32 v146, v146, v136
    v_mul_f32 v147, v147, v136
    v_mul_f32 v148, v148, v136
    v_mul_f32 v149, v149, v136
    v_mfma_f32_32x32x16_bf16 v[240:255], v[108:111], v[44:47], v[240:255]
    v_mul_f32 v150, v150, v136
    v_mul_f32 v151, v151, v136
    v_cvt_pk_bf16_f32 v52, v144, v145
    v_cvt_pk_bf16_f32 v53, v146, v147
    v_cvt_pk_bf16_f32 v54, v148, v149
    v_cvt_pk_bf16_f32 v55, v150, v151
    s_waitcnt lgkmcnt(0)
    v_mfma_f32_32x32x16_bf16 v[192:207], v[112:115], v[48:51], v[192:207]
    v_xor_b32 v24, 0, v22
    v_xor_b32 v25, 32, v22
    v_xor_b32 v26, 64, v22
    v_xor_b32 v27, 96, v22
    v_mfma_f32_32x32x16_bf16 v[208:223], v[112:115], v[52:55], v[208:223]
    v_xor_b32 v28, 65536, v22
    v_xor_b32 v29, 65568, v22
    v_xor_b32 v30, 65600, v22
    v_xor_b32 v31, 65632, v22
    s_nop 2
    ds_write_b128 v24, v[192:195]
    ds_write_b128 v25, v[196:199]
    ds_write_b128 v26, v[200:203]
    ds_write_b128 v27, v[204:207]
    v_mfma_f32_32x32x16_bf16 v[224:239], v[116:119], v[48:51], v[224:239]
    v_xor_b32 v32, 128, v22
    v_xor_b32 v33, 160, v22
    v_xor_b32 v34, 192, v22
    v_xor_b32 v35, 224, v22
    ds_write_b128 v28, v[208:211]
    ds_write_b128 v29, v[212:215]
    ds_write_b128 v30, v[216:219]
    ds_write_b128 v31, v[220:223]
    v_mfma_f32_32x32x16_bf16 v[240:255], v[116:119], v[52:55], v[240:255]
    v_xor_b32 v36, 65664, v22
    v_xor_b32 v37, 65696, v22
    v_xor_b32 v38, 65728, v22
    v_xor_b32 v39, 65760, v22
    ds_write_b128 v32, v[224:227]
    ds_write_b128 v33, v[228:231]
    ds_write_b128 v34, v[232:235]
    ds_write_b128 v35, v[236:239]
    s_nop 3
    ds_write_b128 v36, v[240:243]
    ds_write_b128 v37, v[244:247]
    ds_write_b128 v38, v[248:251]
    ds_write_b128 v39, v[252:255]
    s_waitcnt lgkmcnt(0)
    s_barrier
    ds_read_b128 v[40:43], v21 offset:0
    ds_read_b128 v[44:47], v20 offset:0
    ds_read_b128 v[48:51], v21 offset:2048
    ds_read_b128 v[52:55], v20 offset:2048
    ds_read_b128 v[56:59], v21 offset:4096
    ds_read_b128 v[60:63], v20 offset:4096
    ds_read_b128 v[64:67], v21 offset:6144
    ds_read_b128 v[68:71], v20 offset:6144
    ds_read_b128 v[72:75], v21 offset:8192
    ds_read_b128 v[76:79], v20 offset:8192
    ds_read_b128 v[80:83], v21 offset:10240
    ds_read_b128 v[84:87], v20 offset:10240
    ds_read_b128 v[88:91], v21 offset:12288
    ds_read_b128 v[92:95], v20 offset:12288
    ds_read_b128 v[96:99], v21 offset:14336
    ds_read_b128 v[100:103], v20 offset:14336
    s_waitcnt vmcnt(0)
    v_lshlrev_b32 v104, 16, v12
    v_and_b32 v105, 0xffff0000, v12
    v_lshlrev_b32 v112, 16, v16
    v_and_b32 v113, 0xffff0000, v16
    v_lshlrev_b32 v106, 16, v13
    v_and_b32 v107, 0xffff0000, v13
    v_lshlrev_b32 v114, 16, v17
    v_and_b32 v115, 0xffff0000, v17
    v_lshlrev_b32 v108, 16, v14
    v_and_b32 v109, 0xffff0000, v14
    v_lshlrev_b32 v116, 16, v18
    v_and_b32 v117, 0xffff0000, v18
    v_lshlrev_b32 v110, 16, v15
    v_and_b32 v111, 0xffff0000, v15
    v_lshlrev_b32 v118, 16, v19
    v_and_b32 v119, 0xffff0000, v19
    v_pk_add_f32 v[104:105], v[104:105], v[112:113]
    v_pk_add_f32 v[106:107], v[106:107], v[114:115]
    v_pk_add_f32 v[108:109], v[108:109], v[116:117]
    v_pk_add_f32 v[110:111], v[110:111], v[118:119]
    s_waitcnt lgkmcnt(14)
    v_pk_add_f32 v[104:105], v[104:105], v[40:41]
    v_pk_add_f32 v[106:107], v[106:107], v[42:43]
    v_pk_add_f32 v[108:109], v[108:109], v[44:45]
    v_pk_add_f32 v[110:111], v[110:111], v[46:47]
    s_waitcnt lgkmcnt(12)
    v_pk_add_f32 v[104:105], v[104:105], v[48:49]
    v_pk_add_f32 v[106:107], v[106:107], v[50:51]
    v_pk_add_f32 v[108:109], v[108:109], v[52:53]
    v_pk_add_f32 v[110:111], v[110:111], v[54:55]
    s_waitcnt lgkmcnt(10)
    v_pk_add_f32 v[104:105], v[104:105], v[56:57]
    v_pk_add_f32 v[106:107], v[106:107], v[58:59]
    v_pk_add_f32 v[108:109], v[108:109], v[60:61]
    v_pk_add_f32 v[110:111], v[110:111], v[62:63]
    s_waitcnt lgkmcnt(8)
    v_pk_add_f32 v[104:105], v[104:105], v[64:65]
    v_pk_add_f32 v[106:107], v[106:107], v[66:67]
    v_pk_add_f32 v[108:109], v[108:109], v[68:69]
    v_pk_add_f32 v[110:111], v[110:111], v[70:71]
    s_waitcnt lgkmcnt(6)
    v_pk_add_f32 v[104:105], v[104:105], v[72:73]
    v_pk_add_f32 v[106:107], v[106:107], v[74:75]
    v_pk_add_f32 v[108:109], v[108:109], v[76:77]
    v_pk_add_f32 v[110:111], v[110:111], v[78:79]
    s_waitcnt lgkmcnt(4)
    v_pk_add_f32 v[104:105], v[104:105], v[80:81]
    v_pk_add_f32 v[106:107], v[106:107], v[82:83]
    v_pk_add_f32 v[108:109], v[108:109], v[84:85]
    v_pk_add_f32 v[110:111], v[110:111], v[86:87]
    s_waitcnt lgkmcnt(2)
    v_pk_add_f32 v[104:105], v[104:105], v[88:89]
    v_pk_add_f32 v[106:107], v[106:107], v[90:91]
    v_pk_add_f32 v[108:109], v[108:109], v[92:93]
    v_pk_add_f32 v[110:111], v[110:111], v[94:95]
    s_waitcnt lgkmcnt(0)
    v_pk_add_f32 v[104:105], v[104:105], v[96:97]
    v_pk_add_f32 v[106:107], v[106:107], v[98:99]
    v_pk_add_f32 v[108:109], v[108:109], v[100:101]
    v_pk_add_f32 v[110:111], v[110:111], v[102:103]
    v_cvt_pk_bf16_f32 v112, v104, v105
    v_cvt_pk_bf16_f32 v113, v106, v107
    v_cvt_pk_bf16_f32 v114, v108, v109
    v_cvt_pk_bf16_f32 v115, v110, v111
    buffer_store_dwordx4 v[112:115], v11, s[28:31], s58 offen
    s_endpgm
L_exit:
    s_endpgm
.section .rodata,"a"
.p2align 6
.amdhsa_kernel parallel_sum__linear_attn_block__dense_activation_gelu__prompt_kernel
  .amdhsa_next_free_vgpr 256
  .amdhsa_next_free_sgpr 102
  .amdhsa_accum_offset 256
  .amdhsa_group_segment_fixed_size 0
  .amdhsa_kernarg_size 88
  .amdhsa_user_sgpr_count 2
  .amdhsa_user_sgpr_kernarg_segment_ptr 1
  .amdhsa_system_sgpr_workgroup_id_x 1
.end_amdhsa_kernel
```
